```python
import torch

def _softmax(x, axis=-1):
    return torch.softmax(x, dim=axis)
def _gelu(x):
    return torch.nn.functional.gelu(x, approximate="tanh")
def _silu(x):
    return torch.nn.functional.silu(x)
def _sigmoid(x):
    return torch.sigmoid(x)
def _layernorm(x, axis=-1, eps=1e-5):
    m = x.mean(dim=axis, keepdim=True)
    v = x.var(dim=axis, keepdim=True, unbiased=False)
    return (x - m) / torch.sqrt(v + eps)
def _scatter_add(tgt, idx, src, axis=0):
    return tgt.clone().index_add_(axis, idx, src)
def _segment_sum(src, seg, n):
    out = torch.zeros((n,) + src.shape[1:], dtype=src.dtype)
    return out.index_add_(0, seg, src)
def _pad(x, pw):
    flat = tuple(v for pair in reversed(pw) for v in pair)
    return torch.nn.functional.pad(x, flat)

kernel_name = 'sequential_preLN__mha_block_cached__dense_activation_gelu__decode'

def setup_inputs():

    _w = (lambda a: (lambda t: t.to(torch.bfloat16) if t.is_floating_point() else t)(torch.as_tensor(a)))
    def _A_setup():
        B, Sq, D = 1, 1, 640
        H, Sk, Dh = 32, 32768, 128
        return {
            "x": _w((lambda *s: torch.randn(*s, dtype=torch.bfloat16) * 0.1)(B, Sq, D)),
            "k_cache": _w((lambda *s: torch.randn(*s, dtype=torch.bfloat16) * 1.6)(B, H, Sk, Dh)),
            "v_cache": _w((lambda *s: torch.randn(*s, dtype=torch.bfloat16) * 1.6)(B, H, Sk, Dh)),
            "wq": _w((lambda *s: torch.randn(*s, dtype=torch.bfloat16) * 1.6)(D, H * Dh) * (D ** -0.5)),
            "wo": _w((lambda *s: torch.randn(*s, dtype=torch.bfloat16) * 1.6)(H * Dh, D) * ((H * Dh) ** -0.5)),
        }
    _A_in = _A_setup()

    def _B_setup():
        B, S, D, F = 1, 1, 640, 1728
        return {
            "x": _w((lambda *s: torch.randn(*s, dtype=torch.bfloat16) * 0.1)(B, S, D)),
            "w1": _w((lambda *s: torch.randn(*s, dtype=torch.bfloat16) * 3.2)(D, F) * (D ** -0.5)),
            "b1": _w((lambda *s: torch.randn(*s, dtype=torch.bfloat16) * 3.2)(F) * 0.01),
            "w2": _w((lambda *s: torch.randn(*s, dtype=torch.bfloat16) * 3.2)(F, D) * (F ** -0.5)),
            "b2": _w((lambda *s: torch.randn(*s, dtype=torch.bfloat16) * 3.2)(D) * 0.01),
        }
    _B_in = _B_setup()

    return {
        "A_x": _A_in["x"],
        "A_k_cache": _A_in["k_cache"],
        "A_v_cache": _A_in["v_cache"],
        "A_wq": _A_in["wq"],
        "A_wo": _A_in["wo"],
        "B_x": _B_in["x"],
        "B_w1": _B_in["w1"],
        "B_b1": _B_in["b1"],
        "B_w2": _B_in["w2"],
        "B_b2": _B_in["b2"],
    }

def reference(A_x, A_k_cache, A_v_cache, A_wq, A_wo, B_x, B_w1, B_b1, B_w2, B_b2):
    def _A_ref(x, k_cache, v_cache, wq, wo):
        B, Sq, D = x.shape
        H, Dh = 32, 128
        q = (lambda x, *d: x.permute(*d))((x @ wq).reshape(B, Sq, H, Dh), 0, 2, 1, 3)
        scores = torch.einsum("bhqd,bhkd->bhqk", q, k_cache) * (Dh ** -0.5)
        p = _softmax(scores, axis=-1)
        o = torch.einsum("bhqk,bhkd->bhqd", p, v_cache)
        return (lambda x, *d: x.permute(*d))(o, 0, 2, 1, 3).reshape(B, Sq, H * Dh) @ wo

    def _B_ref(x, w1, b1, w2, b2):
        h = torch.einsum("bsd,df->bsf", x, w1) + b1
        h = _gelu(h)
        return torch.einsum("bsf,fd->bsd", h, w2) + b2

    x = A_x
    h = x + _A_ref(_layernorm(x, axis=-1), A_k_cache, A_v_cache, A_wq, A_wo)
    h2 = h + _B_ref(_layernorm(h, axis=-1), B_w1, B_b1, B_w2, B_b2)
    return h2
```

```asm
; @launch grid=(256,1,1) block=(576,1,1) lds=8448
.amdgcn_target "amdgcn-amd-amdhsa--gfx950"
.text
.globl sequential_preLN__mha_block_cached__dense_activation_gelu__decode_kernel
.p2align 8
.type sequential_preLN__mha_block_cached__dense_activation_gelu__decode_kernel,@function
sequential_preLN__mha_block_cached__dense_activation_gelu__decode_kernel:
    s_cmp_ge_u32 s2, 0x100
    s_cbranch_scc1 L_end
    s_load_dwordx16 s[16:31], s[0:1], 0
    s_load_dwordx8 s[32:39], s[0:1], 64
    s_load_dwordx2 s[40:41], s[0:1], 96
    v_lshrrev_b32 v1, 6, v0
    v_and_b32 v0, 63, v0
    s_nop 0
    v_readfirstlane_b32 s5, v1
    s_and_b32 s4, s2, 7
    s_lshr_b32 s3, s2, 3
    s_mul_i32 s14, s4, 5
    s_add_u32 s3, s3, s14
    s_and_b32 s3, s3, 31
    s_mov_b32 s12, 0x3fb8aa3b
    s_mov_b32 s13, 0x3db504f3
    s_mov_b32 s72, 0xffff0000
    s_lshl_b32 s75, s3, 3
    s_add_u32 s75, s75, s4
    s_waitcnt lgkmcnt(0)
    s_mov_b32 s52, s40
    s_and_b32 s53, s41, 0xffff
    s_mov_b32 s54, 0x200000
    s_mov_b32 s55, 0x20000
    s_cmp_eq_u32 s5, 0
    s_cbranch_scc1 L_helper
    s_sub_u32 s81, s5, 1
    s_lshl_b32 s14, s3, 23
    s_add_u32 s44, s18, s14
    s_addc_u32 s45, s19, 0
    s_and_b32 s45, s45, 0xffff
    s_mov_b32 s46, 0x800000
    s_mov_b32 s47, 0x20000
    s_add_u32 s48, s20, s14
    s_addc_u32 s49, s21, 0
    s_and_b32 s49, s49, 0xffff
    s_mov_b32 s50, 0x800000
    s_mov_b32 s51, 0x20000
    s_lshl_b32 s6, s4, 3
    s_add_u32 s6, s6, s81
    v_lshlrev_b32 v1, 4, v0
    s_mul_i32 s82, s3, 256
    s_add_u32 s82, s82, 0x10000
    s_and_b32 s14, s81, 0
    s_lshl_b32 s14, s14, 8
    s_add_u32 s82, s82, s14
    v_mov_b32 v32, 0xff800000
    v_mov_b32 v33, 0
    v_mov_b32 v24, 0
    v_mov_b32 v25, 0
    v_mov_b32 v26, 0
    v_mov_b32 v27, 0
    v_mov_b32 v28, 0
    v_mov_b32 v29, 0
    v_mov_b32 v30, 0
    v_mov_b32 v31, 0
    s_barrier
    v_lshrrev_b32 v2, 2, v0
    v_and_b32 v3, 3, v0
    s_cmp_lt_u32 s2, 160
    s_cbranch_scc1 L_w_wo
    s_cmp_lt_u32 s2, 214
    s_cbranch_scc1 L_w_ff
    s_branch L_w_done
L_w_wo:
    s_mov_b32 s56, s24
    s_and_b32 s57, s25, 0xffff
    s_mov_b32 s58, 0x500000
    s_mov_b32 s59, 0x20000
    s_and_b32 s73, s2, 7
    s_lshr_b32 s74, s2, 3
    s_lshl_b32 s14, s73, 3
    s_add_u32 s14, s14, s81
    s_mul_i32 s14, s14, 81920
    s_lshl_b32 s15, s74, 6
    s_add_u32 s14, s14, s15
    v_mul_u32_u24 v38, 0x1400, v2
    v_lshl_add_u32 v38, v3, 4, v38
    buffer_load_dwordx4 v[40:43], v38, s[56:59], s14 offen offset:0 nt
    buffer_load_dwordx4 v[44:47], v38, s[56:59], s14 offen offset:1280 nt
    buffer_load_dwordx4 v[48:51], v38, s[56:59], s14 offen offset:2560 nt
    buffer_load_dwordx4 v[52:55], v38, s[56:59], s14 offen offset:3840 nt
    s_branch L_w_done
L_w_ff:
    s_mov_b32 s56, s28
    s_and_b32 s57, s29, 0xffff
    s_mov_b32 s58, 0x21c000
    s_mov_b32 s59, 0x20000
    s_mov_b32 s60, s32
    s_and_b32 s61, s33, 0xffff
    s_mov_b32 s62, 0x21c000
    s_mov_b32 s63, 0x20000
    s_mov_b32 s64, s16
    s_and_b32 s65, s17, 0xffff
    s_mov_b32 s66, 0x500
    s_mov_b32 s67, 0x20000
    s_mov_b32 s68, s30
    s_and_b32 s69, s31, 0xffff
    s_mov_b32 s70, 0xd80
    s_mov_b32 s71, 0x20000
    s_sub_u32 s73, s2, 160
    s_and_b32 s14, s73, 7
    s_lshl_b32 s14, s14, 1
    s_bfe_u32 s15, s73, 0x10003
    s_add_u32 s14, s14, s15
    s_and_b32 s15, s73, 48
    s_add_u32 s14, s14, s15
    s_cmp_lt_u32 s73, 48
    s_cselect_b32 s73, s14, s73
    s_mul_i32 s14, s81, 276480
    s_lshl_b32 s15, s73, 6
    s_add_u32 s14, s14, s15
    v_mul_u32_u24 v38, 0xd80, v2
    v_lshl_add_u32 v38, v3, 4, v38
    buffer_load_dwordx4 v[40:43], v38, s[56:59], s14 offen nt
    s_add_u32 s14, s14, 55296
    buffer_load_dwordx4 v[44:47], v38, s[56:59], s14 offen nt
    s_add_u32 s14, s14, 55296
    buffer_load_dwordx4 v[48:51], v38, s[56:59], s14 offen nt
    s_add_u32 s14, s14, 55296
    buffer_load_dwordx4 v[52:55], v38, s[56:59], s14 offen nt
    s_add_u32 s14, s14, 55296
    s_waitcnt vmcnt(3)
    buffer_load_dwordx4 v[56:59], v38, s[56:59], s14 offen nt
    s_waitcnt vmcnt(3)
    v_and_b32 v39, 7, v0
    v_and_b32 v38, 48, v0
    v_lshl_add_u32 v39, v39, 1, v38
    buffer_load_ushort v93, v39, s[68:71], s15 offen
    s_lshl_b32 s15, s81, 8
    v_lshl_add_u32 v39, v0, 2, s15
    buffer_load_dword v92, v39, s[64:67], 0 offen
    s_mul_i32 s14, s73, 40960
    s_add_u32 s14, s14, s15
    s_cmp_lt_u32 s81, 5
    s_cselect_b32 s15, 0, 0x40000000
    v_lshrrev_b32 v38, 4, v0
    v_mul_u32_u24 v38, 0x2800, v38
    v_and_b32 v39, 15, v0
    v_lshl_add_u32 v38, v39, 4, v38
    v_add_u32 v38, s15, v38
    buffer_load_dwordx4 v[60:63], v38, s[60:63], s14 offen nt
    s_add_u32 s14, s14, 1280
    s_waitcnt vmcnt(3)
    buffer_load_dwordx4 v[64:67], v38, s[60:63], s14 offen nt
    s_add_u32 s14, s14, 1280
    s_waitcnt vmcnt(3)
    buffer_load_dwordx4 v[68:71], v38, s[60:63], s14 offen nt
    s_add_u32 s14, s14, 1280
    s_waitcnt vmcnt(3)
    buffer_load_dwordx4 v[72:75], v38, s[60:63], s14 offen nt
    s_add_u32 s14, s14, 1280
    s_waitcnt vmcnt(3)
    buffer_load_dwordx4 v[76:79], v38, s[60:63], s14 offen nt
    s_add_u32 s14, s14, 1280
    s_waitcnt vmcnt(3)
    buffer_load_dwordx4 v[80:83], v38, s[60:63], s14 offen nt
    s_add_u32 s14, s14, 1280
    s_waitcnt vmcnt(3)
    buffer_load_dwordx4 v[84:87], v38, s[60:63], s14 offen nt
    s_add_u32 s14, s14, 1280
    s_waitcnt vmcnt(3)
    buffer_load_dwordx4 v[88:91], v38, s[60:63], s14 offen nt
    s_waitcnt vmcnt(3)
L_w_done:
    s_mul_i32 s95, s3, 786432
    s_and_b32 s95, s95, 0x7ff000
    s_bfe_u32 s88, s6, 0x30000
    s_lshl_b32 s88, s88, 14
    s_add_u32 s8, s95, s88
    s_bfe_u32 s88, s6, 0x20003
    s_lshl_b32 s88, s88, 21
    s_add_u32 s8, s8, s88
    s_bfe_u32 s88, s6, 0x20005
    s_lshl_b32 s88, s88, 12
    s_add_u32 s8, s8, s88
    s_bfe_u32 s88, s6, 0x40007
    s_lshl_b32 s88, s88, 17
    s_add_u32 s8, s8, s88
    s_and_b32 s8, s8, 0x7fffff
    s_waitcnt vmcnt(3)
    buffer_load_dwordx4 v[104:107], v1, s[44:47], s8 offen offset:0 nt
    s_waitcnt vmcnt(3)
    buffer_load_dwordx4 v[108:111], v1, s[44:47], s8 offen offset:1024 nt
    s_waitcnt vmcnt(3)
    buffer_load_dwordx4 v[112:115], v1, s[44:47], s8 offen offset:2048 nt
    s_waitcnt vmcnt(3)
    buffer_load_dwordx4 v[116:119], v1, s[44:47], s8 offen offset:3072 nt
    s_waitcnt vmcnt(3)
    buffer_load_dwordx4 v[120:123], v1, s[48:51], s8 offen offset:0 nt
    s_waitcnt vmcnt(3)
    buffer_load_dwordx4 v[124:127], v1, s[48:51], s8 offen offset:1024 nt
    s_waitcnt vmcnt(3)
    buffer_load_dwordx4 v[128:131], v1, s[48:51], s8 offen offset:2048 nt
    s_waitcnt vmcnt(3)
    buffer_load_dwordx4 v[132:135], v1, s[48:51], s8 offen offset:3072 nt
    s_waitcnt vmcnt(3)
    s_add_u32 s6, s6, 64
    s_bfe_u32 s88, s6, 0x30000
    s_lshl_b32 s88, s88, 14
    s_add_u32 s8, s95, s88
    s_bfe_u32 s88, s6, 0x20003
    s_lshl_b32 s88, s88, 21
    s_add_u32 s8, s8, s88
    s_bfe_u32 s88, s6, 0x20005
    s_lshl_b32 s88, s88, 12
    s_add_u32 s8, s8, s88
    s_bfe_u32 s88, s6, 0x40007
    s_lshl_b32 s88, s88, 17
    s_add_u32 s8, s8, s88
    s_and_b32 s8, s8, 0x7fffff
    buffer_load_dwordx4 v[136:139], v1, s[44:47], s8 offen offset:0 nt
    s_waitcnt vmcnt(3)
    buffer_load_dwordx4 v[140:143], v1, s[44:47], s8 offen offset:1024 nt
    s_waitcnt vmcnt(3)
    buffer_load_dwordx4 v[144:147], v1, s[44:47], s8 offen offset:2048 nt
    s_waitcnt vmcnt(3)
    buffer_load_dwordx4 v[148:151], v1, s[44:47], s8 offen offset:3072 nt
    s_waitcnt vmcnt(3)
    buffer_load_dwordx4 v[152:155], v1, s[48:51], s8 offen offset:0 nt
    s_waitcnt vmcnt(3)
    buffer_load_dwordx4 v[156:159], v1, s[48:51], s8 offen offset:1024 nt
    s_waitcnt vmcnt(3)
    buffer_load_dwordx4 v[160:163], v1, s[48:51], s8 offen offset:2048 nt
    s_waitcnt vmcnt(3)
    buffer_load_dwordx4 v[164:167], v1, s[48:51], s8 offen offset:3072 nt
    v_and_b32 v96, 15, v0
    v_lshrrev_b32 v99, 4, v0
    v_lshlrev_b32 v99, 3, v99
    v_lshl_add_u32 v96, v96, 5, v99
    s_lshl_b32 s14, s81, 9
    v_add_u32 v97, s14, v96
    s_lshl_b32 s14, s81, 3
    v_mov_b32 v98, s14
    s_mov_b32 s84, 0x05040100
    s_mov_b32 s85, 0x07060302
    v_perm_b32 v2, v44, v40, s84
    v_perm_b32 v44, v44, v40, s85
    v_mov_b32 v40, v2
    v_perm_b32 v2, v45, v41, s84
    v_perm_b32 v45, v45, v41, s85
    v_mov_b32 v41, v2
    v_perm_b32 v2, v46, v42, s84
    v_perm_b32 v46, v46, v42, s85
    v_mov_b32 v42, v2
    v_perm_b32 v2, v47, v43, s84
    v_perm_b32 v47, v47, v43, s85
    v_mov_b32 v43, v2
    v_perm_b32 v2, v52, v48, s84
    v_perm_b32 v52, v52, v48, s85
    v_mov_b32 v48, v2
    v_perm_b32 v2, v53, v49, s84
    v_perm_b32 v53, v53, v49, s85
    v_mov_b32 v49, v2
    v_perm_b32 v2, v54, v50, s84
    v_perm_b32 v54, v54, v50, s85
    v_mov_b32 v50, v2
    v_perm_b32 v2, v55, v51, s84
    v_perm_b32 v55, v55, v51, s85
    v_mov_b32 v51, v2
    v_perm_b32 v2, v64, v60, s84
    v_perm_b32 v64, v64, v60, s85
    v_mov_b32 v60, v2
    v_perm_b32 v2, v65, v61, s84
    v_perm_b32 v65, v65, v61, s85
    v_mov_b32 v61, v2
    v_perm_b32 v2, v66, v62, s84
    v_perm_b32 v66, v66, v62, s85
    v_mov_b32 v62, v2
    v_perm_b32 v2, v67, v63, s84
    v_perm_b32 v67, v67, v63, s85
    v_mov_b32 v63, v2
    v_perm_b32 v2, v72, v68, s84
    v_perm_b32 v72, v72, v68, s85
    v_mov_b32 v68, v2
    v_perm_b32 v2, v73, v69, s84
    v_perm_b32 v73, v73, v69, s85
    v_mov_b32 v69, v2
    v_perm_b32 v2, v74, v70, s84
    v_perm_b32 v74, v74, v70, s85
    v_mov_b32 v70, v2
    v_perm_b32 v2, v75, v71, s84
    v_perm_b32 v75, v75, v71, s85
    v_mov_b32 v71, v2
    v_perm_b32 v2, v80, v76, s84
    v_perm_b32 v80, v80, v76, s85
    v_mov_b32 v76, v2
    v_perm_b32 v2, v81, v77, s84
    v_perm_b32 v81, v81, v77, s85
    v_mov_b32 v77, v2
    v_perm_b32 v2, v82, v78, s84
    v_perm_b32 v82, v82, v78, s85
    v_mov_b32 v78, v2
    v_perm_b32 v2, v83, v79, s84
    v_perm_b32 v83, v83, v79, s85
    v_mov_b32 v79, v2
    v_perm_b32 v2, v88, v84, s84
    v_perm_b32 v88, v88, v84, s85
    v_mov_b32 v84, v2
    v_perm_b32 v2, v89, v85, s84
    v_perm_b32 v89, v89, v85, s85
    v_mov_b32 v85, v2
    v_perm_b32 v2, v90, v86, s84
    v_perm_b32 v90, v90, v86, s85
    v_mov_b32 v86, v2
    v_perm_b32 v2, v91, v87, s84
    v_perm_b32 v91, v91, v87, s85
    v_mov_b32 v87, v2
    v_and_b32 v2, 15, v0
    v_lshlrev_b32 v2, 4, v2
    v_mov_b32 v3, 0
    s_add_u32 s6, s6, 64
    s_bfe_u32 s88, s6, 0x30000
    s_lshl_b32 s88, s88, 14
    s_add_u32 s8, s95, s88
    s_bfe_u32 s88, s6, 0x20003
    s_lshl_b32 s88, s88, 21
    s_add_u32 s8, s8, s88
    s_bfe_u32 s88, s6, 0x20005
    s_lshl_b32 s88, s88, 12
    s_add_u32 s8, s8, s88
    s_bfe_u32 s88, s6, 0x40007
    s_lshl_b32 s88, s88, 17
    s_add_u32 s8, s8, s88
    s_and_b32 s8, s8, 0x7fffff
L_qw:
    ds_read_b32 v4, v3 offset:8320
    s_waitcnt lgkmcnt(0)
    v_cmp_eq_u32 vcc, 0, v4
    s_cbranch_vccz L_qw_x
    s_sleep 2
    s_branch L_qw
L_qw_x:
    ds_read_b128 v[4:7], v2 offset:0
    s_waitcnt lgkmcnt(0)
    v_mov_b32 v3, 1
    s_mov_b64 exec, 1
    buffer_atomic_add v3, off, s[52:55], s82 sc0 sc1
    s_mov_b64 exec, -1
    s_waitcnt vmcnt(9)
    v_dot2_f32_bf16 v8, v104, v4, 0
    v_dot2_f32_bf16 v9, v108, v4, 0
    v_dot2_f32_bf16 v10, v112, v4, 0
    v_dot2_f32_bf16 v11, v116, v4, 0
    v_dot2_f32_bf16 v8, v105, v5, v8
    v_dot2_f32_bf16 v9, v109, v5, v9
    v_dot2_f32_bf16 v10, v113, v5, v10
    v_dot2_f32_bf16 v11, v117, v5, v11
    v_dot2_f32_bf16 v8, v106, v6, v8
    v_dot2_f32_bf16 v9, v110, v6, v9
    v_dot2_f32_bf16 v10, v114, v6, v10
    v_dot2_f32_bf16 v11, v118, v6, v11
    v_dot2_f32_bf16 v8, v107, v7, v8
    v_dot2_f32_bf16 v9, v111, v7, v9
    v_dot2_f32_bf16 v10, v115, v7, v10
    v_dot2_f32_bf16 v11, v119, v7, v11
    s_nop 2
    v_add_f32 v8, v8, v8 row_ror:8 row_mask:0xf bank_mask:0xf
    v_add_f32 v9, v9, v9 row_ror:8 row_mask:0xf bank_mask:0xf
    v_add_f32 v10, v10, v10 row_ror:8 row_mask:0xf bank_mask:0xf
    v_add_f32 v11, v11, v11 row_ror:8 row_mask:0xf bank_mask:0xf
    v_add_f32 v8, v8, v8 row_ror:4 row_mask:0xf bank_mask:0xf
    v_add_f32 v9, v9, v9 row_ror:4 row_mask:0xf bank_mask:0xf
    v_add_f32 v10, v10, v10 row_ror:4 row_mask:0xf bank_mask:0xf
    v_add_f32 v11, v11, v11 row_ror:4 row_mask:0xf bank_mask:0xf
    v_add_f32 v8, v8, v8 row_ror:2 row_mask:0xf bank_mask:0xf
    v_add_f32 v9, v9, v9 row_ror:2 row_mask:0xf bank_mask:0xf
    v_add_f32 v10, v10, v10 row_ror:2 row_mask:0xf bank_mask:0xf
    v_add_f32 v11, v11, v11 row_ror:2 row_mask:0xf bank_mask:0xf
    v_add_f32 v8, v8, v8 row_ror:1 row_mask:0xf bank_mask:0xf
    v_add_f32 v9, v9, v9 row_ror:1 row_mask:0xf bank_mask:0xf
    v_add_f32 v10, v10, v10 row_ror:1 row_mask:0xf bank_mask:0xf
    v_add_f32 v11, v11, v11 row_ror:1 row_mask:0xf bank_mask:0xf
    v_cvt_pk_bf16_f32 v8, 0, v8
    v_cvt_pk_bf16_f32 v9, 0, v9
    v_cvt_pk_bf16_f32 v10, 0, v10
    v_cvt_pk_bf16_f32 v11, 0, v11
    v_mul_f32 v8, s13, v8
    v_mul_f32 v9, s13, v9
    v_mul_f32 v10, s13, v10
    v_mul_f32 v11, s13, v11
    v_cvt_pk_bf16_f32 v8, 0, v8
    v_cvt_pk_bf16_f32 v9, 0, v9
    v_cvt_pk_bf16_f32 v10, 0, v10
    v_cvt_pk_bf16_f32 v11, 0, v11
    v_max3_f32 v35, v8, v9, v32
    v_max_f32 v36, v10, v11
    v_max_f32 v35, v35, v36
    v_mul_f32 v34, s12, v35
    v_fma_f32 v36, v32, s12, -v34
    v_mov_b32 v32, v35
    v_exp_f32 v36, v36
    v_fma_f32 v8, v8, s12, -v34
    v_fma_f32 v9, v9, s12, -v34
    v_fma_f32 v10, v10, s12, -v34
    v_fma_f32 v11, v11, s12, -v34
    v_exp_f32 v8, v8
    v_exp_f32 v9, v9
    v_exp_f32 v10, v10
    v_exp_f32 v11, v11
    v_mul_f32 v24, v24, v36
    v_mul_f32 v25, v25, v36
    v_mul_f32 v26, v26, v36
    v_mul_f32 v27, v27, v36
    v_mul_f32 v28, v28, v36
    v_mul_f32 v29, v29, v36
    v_mul_f32 v30, v30, v36
    v_mul_f32 v31, v31, v36
    v_fma_f32 v33, v33, v36, v8
    v_add_f32 v35, v9, v10
    v_add_f32 v33, v33, v11
    v_add_f32 v33, v33, v35
    v_cvt_pk_bf16_f32 v36, v8, 0
    v_cvt_pk_bf16_f32 v8, 0, v8
    v_cvt_pk_bf16_f32 v37, v9, 0
    v_cvt_pk_bf16_f32 v9, 0, v9
    v_cvt_pk_bf16_f32 v38, v10, 0
    v_cvt_pk_bf16_f32 v10, 0, v10
    v_cvt_pk_bf16_f32 v39, v11, 0
    v_cvt_pk_bf16_f32 v11, 0, v11
    buffer_load_dwordx4 v[104:107], v1, s[44:47], s8 offen offset:0 nt
    buffer_load_dwordx4 v[108:111], v1, s[44:47], s8 offen offset:1024 nt
    buffer_load_dwordx4 v[112:115], v1, s[44:47], s8 offen offset:2048 nt
    buffer_load_dwordx4 v[116:119], v1, s[44:47], s8 offen offset:3072 nt
    v_dot2_f32_bf16 v24, v120, v36, v24
    v_dot2_f32_bf16 v25, v120, v8, v25
    v_dot2_f32_bf16 v26, v121, v36, v26
    v_dot2_f32_bf16 v27, v121, v8, v27
    v_dot2_f32_bf16 v28, v122, v36, v28
    v_dot2_f32_bf16 v29, v122, v8, v29
    v_dot2_f32_bf16 v30, v123, v36, v30
    v_dot2_f32_bf16 v31, v123, v8, v31
    v_dot2_f32_bf16 v24, v124, v37, v24
    v_dot2_f32_bf16 v25, v124, v9, v25
    v_dot2_f32_bf16 v26, v125, v37, v26
    v_dot2_f32_bf16 v27, v125, v9, v27
    v_dot2_f32_bf16 v28, v126, v37, v28
    v_dot2_f32_bf16 v29, v126, v9, v29
    v_dot2_f32_bf16 v30, v127, v37, v30
    v_dot2_f32_bf16 v31, v127, v9, v31
    v_dot2_f32_bf16 v24, v128, v38, v24
    v_dot2_f32_bf16 v25, v128, v10, v25
    v_dot2_f32_bf16 v26, v129, v38, v26
    v_dot2_f32_bf16 v27, v129, v10, v27
    v_dot2_f32_bf16 v28, v130, v38, v28
    v_dot2_f32_bf16 v29, v130, v10, v29
    v_dot2_f32_bf16 v30, v131, v38, v30
    v_dot2_f32_bf16 v31, v131, v10, v31
    v_dot2_f32_bf16 v24, v132, v39, v24
    v_dot2_f32_bf16 v25, v132, v11, v25
    v_dot2_f32_bf16 v26, v133, v39, v26
    v_dot2_f32_bf16 v27, v133, v11, v27
    v_dot2_f32_bf16 v28, v134, v39, v28
    v_dot2_f32_bf16 v29, v134, v11, v29
    v_dot2_f32_bf16 v30, v135, v39, v30
    v_dot2_f32_bf16 v31, v135, v11, v31
    buffer_load_dwordx4 v[120:123], v1, s[48:51], s8 offen offset:0 nt
    buffer_load_dwordx4 v[124:127], v1, s[48:51], s8 offen offset:1024 nt
    buffer_load_dwordx4 v[128:131], v1, s[48:51], s8 offen offset:2048 nt
    buffer_load_dwordx4 v[132:135], v1, s[48:51], s8 offen offset:3072 nt
    s_waitcnt vmcnt(9)
    v_dot2_f32_bf16 v8, v136, v4, 0
    v_dot2_f32_bf16 v9, v140, v4, 0
    v_dot2_f32_bf16 v10, v144, v4, 0
    v_dot2_f32_bf16 v11, v148, v4, 0
    v_dot2_f32_bf16 v8, v137, v5, v8
    v_dot2_f32_bf16 v9, v141, v5, v9
    v_dot2_f32_bf16 v10, v145, v5, v10
    v_dot2_f32_bf16 v11, v149, v5, v11
    v_dot2_f32_bf16 v8, v138, v6, v8
    v_dot2_f32_bf16 v9, v142, v6, v9
    v_dot2_f32_bf16 v10, v146, v6, v10
    v_dot2_f32_bf16 v11, v150, v6, v11
    v_dot2_f32_bf16 v8, v139, v7, v8
    v_dot2_f32_bf16 v9, v143, v7, v9
    v_dot2_f32_bf16 v10, v147, v7, v10
    v_dot2_f32_bf16 v11, v151, v7, v11
    s_nop 2
    v_add_f32 v8, v8, v8 row_ror:8 row_mask:0xf bank_mask:0xf
    v_add_f32 v9, v9, v9 row_ror:8 row_mask:0xf bank_mask:0xf
    v_add_f32 v10, v10, v10 row_ror:8 row_mask:0xf bank_mask:0xf
    v_add_f32 v11, v11, v11 row_ror:8 row_mask:0xf bank_mask:0xf
    v_add_f32 v8, v8, v8 row_ror:4 row_mask:0xf bank_mask:0xf
    v_add_f32 v9, v9, v9 row_ror:4 row_mask:0xf bank_mask:0xf
    v_add_f32 v10, v10, v10 row_ror:4 row_mask:0xf bank_mask:0xf
    v_add_f32 v11, v11, v11 row_ror:4 row_mask:0xf bank_mask:0xf
    v_add_f32 v8, v8, v8 row_ror:2 row_mask:0xf bank_mask:0xf
    v_add_f32 v9, v9, v9 row_ror:2 row_mask:0xf bank_mask:0xf
    v_add_f32 v10, v10, v10 row_ror:2 row_mask:0xf bank_mask:0xf
    v_add_f32 v11, v11, v11 row_ror:2 row_mask:0xf bank_mask:0xf
    v_add_f32 v8, v8, v8 row_ror:1 row_mask:0xf bank_mask:0xf
    v_add_f32 v9, v9, v9 row_ror:1 row_mask:0xf bank_mask:0xf
    v_add_f32 v10, v10, v10 row_ror:1 row_mask:0xf bank_mask:0xf
    v_add_f32 v11, v11, v11 row_ror:1 row_mask:0xf bank_mask:0xf
    v_cvt_pk_bf16_f32 v8, 0, v8
    v_cvt_pk_bf16_f32 v9, 0, v9
    v_cvt_pk_bf16_f32 v10, 0, v10
    v_cvt_pk_bf16_f32 v11, 0, v11
    v_mul_f32 v8, s13, v8
    v_mul_f32 v9, s13, v9
    v_mul_f32 v10, s13, v10
    v_mul_f32 v11, s13, v11
    v_cvt_pk_bf16_f32 v8, 0, v8
    v_cvt_pk_bf16_f32 v9, 0, v9
    v_cvt_pk_bf16_f32 v10, 0, v10
    v_cvt_pk_bf16_f32 v11, 0, v11
    v_max3_f32 v35, v8, v9, v32
    v_max_f32 v36, v10, v11
    v_max_f32 v35, v35, v36
    v_mul_f32 v34, s12, v35
    v_fma_f32 v36, v32, s12, -v34
    v_mov_b32 v32, v35
    v_exp_f32 v36, v36
    v_fma_f32 v8, v8, s12, -v34
    v_fma_f32 v9, v9, s12, -v34
    v_fma_f32 v10, v10, s12, -v34
    v_fma_f32 v11, v11, s12, -v34
    v_exp_f32 v8, v8
    v_exp_f32 v9, v9
    v_exp_f32 v10, v10
    v_exp_f32 v11, v11
    v_mul_f32 v24, v24, v36
    v_mul_f32 v25, v25, v36
    v_mul_f32 v26, v26, v36
    v_mul_f32 v27, v27, v36
    v_mul_f32 v28, v28, v36
    v_mul_f32 v29, v29, v36
    v_mul_f32 v30, v30, v36
    v_mul_f32 v31, v31, v36
    v_fma_f32 v33, v33, v36, v8
    v_add_f32 v35, v9, v10
    v_add_f32 v33, v33, v11
    v_add_f32 v33, v33, v35
    v_cvt_pk_bf16_f32 v36, v8, 0
    v_cvt_pk_bf16_f32 v8, 0, v8
    v_cvt_pk_bf16_f32 v37, v9, 0
    v_cvt_pk_bf16_f32 v9, 0, v9
    v_cvt_pk_bf16_f32 v38, v10, 0
    v_cvt_pk_bf16_f32 v10, 0, v10
    v_cvt_pk_bf16_f32 v39, v11, 0
    v_cvt_pk_bf16_f32 v11, 0, v11
    v_dot2_f32_bf16 v24, v152, v36, v24
    v_dot2_f32_bf16 v25, v152, v8, v25
    v_dot2_f32_bf16 v26, v153, v36, v26
    v_dot2_f32_bf16 v27, v153, v8, v27
    v_dot2_f32_bf16 v28, v154, v36, v28
    v_dot2_f32_bf16 v29, v154, v8, v29
    v_dot2_f32_bf16 v30, v155, v36, v30
    v_dot2_f32_bf16 v31, v155, v8, v31
    v_dot2_f32_bf16 v24, v156, v37, v24
    v_dot2_f32_bf16 v25, v156, v9, v25
    v_dot2_f32_bf16 v26, v157, v37, v26
    v_dot2_f32_bf16 v27, v157, v9, v27
    v_dot2_f32_bf16 v28, v158, v37, v28
    v_dot2_f32_bf16 v29, v158, v9, v29
    v_dot2_f32_bf16 v30, v159, v37, v30
    v_dot2_f32_bf16 v31, v159, v9, v31
    v_dot2_f32_bf16 v24, v160, v38, v24
    v_dot2_f32_bf16 v25, v160, v10, v25
    v_dot2_f32_bf16 v26, v161, v38, v26
    v_dot2_f32_bf16 v27, v161, v10, v27
    v_dot2_f32_bf16 v28, v162, v38, v28
    v_dot2_f32_bf16 v29, v162, v10, v29
    v_dot2_f32_bf16 v30, v163, v38, v30
    v_dot2_f32_bf16 v31, v163, v10, v31
    v_dot2_f32_bf16 v24, v164, v39, v24
    v_dot2_f32_bf16 v25, v164, v11, v25
    v_dot2_f32_bf16 v26, v165, v39, v26
    v_dot2_f32_bf16 v27, v165, v11, v27
    v_dot2_f32_bf16 v28, v166, v39, v28
    v_dot2_f32_bf16 v29, v166, v11, v29
    v_dot2_f32_bf16 v30, v167, v39, v30
    v_dot2_f32_bf16 v31, v167, v11, v31
    s_branch L_eager_body
L_loop:
    v_mov_b32 v3, 1
    s_mov_b64 exec, 1
    buffer_atomic_add v3, off, s[52:55], s82 sc0 sc1
    s_mov_b64 exec, -1
    s_waitcnt vmcnt(1)
L_qk:
    v_dot2_f32_bf16 v8, v104, v4, 0
    v_dot2_f32_bf16 v9, v108, v4, 0
    v_dot2_f32_bf16 v10, v112, v4, 0
    v_dot2_f32_bf16 v11, v116, v4, 0
    v_dot2_f32_bf16 v8, v105, v5, v8
    v_dot2_f32_bf16 v9, v109, v5, v9
    v_dot2_f32_bf16 v10, v113, v5, v10
    v_dot2_f32_bf16 v11, v117, v5, v11
    v_dot2_f32_bf16 v8, v106, v6, v8
    v_dot2_f32_bf16 v9, v110, v6, v9
    v_dot2_f32_bf16 v10, v114, v6, v10
    v_dot2_f32_bf16 v11, v118, v6, v11
    v_dot2_f32_bf16 v8, v107, v7, v8
    v_dot2_f32_bf16 v9, v111, v7, v9
    v_dot2_f32_bf16 v10, v115, v7, v10
    v_dot2_f32_bf16 v11, v119, v7, v11
    s_nop 2
    v_add_f32 v8, v8, v8 row_ror:8 row_mask:0xf bank_mask:0xf
    v_add_f32 v9, v9, v9 row_ror:8 row_mask:0xf bank_mask:0xf
    v_add_f32 v10, v10, v10 row_ror:8 row_mask:0xf bank_mask:0xf
    v_add_f32 v11, v11, v11 row_ror:8 row_mask:0xf bank_mask:0xf
    v_add_f32 v8, v8, v8 row_ror:4 row_mask:0xf bank_mask:0xf
    v_add_f32 v9, v9, v9 row_ror:4 row_mask:0xf bank_mask:0xf
    v_add_f32 v10, v10, v10 row_ror:4 row_mask:0xf bank_mask:0xf
    v_add_f32 v11, v11, v11 row_ror:4 row_mask:0xf bank_mask:0xf
    v_add_f32 v8, v8, v8 row_ror:2 row_mask:0xf bank_mask:0xf
    v_add_f32 v9, v9, v9 row_ror:2 row_mask:0xf bank_mask:0xf
    v_add_f32 v10, v10, v10 row_ror:2 row_mask:0xf bank_mask:0xf
    v_add_f32 v11, v11, v11 row_ror:2 row_mask:0xf bank_mask:0xf
    v_add_f32 v8, v8, v8 row_ror:1 row_mask:0xf bank_mask:0xf
    v_add_f32 v9, v9, v9 row_ror:1 row_mask:0xf bank_mask:0xf
    v_add_f32 v10, v10, v10 row_ror:1 row_mask:0xf bank_mask:0xf
    v_add_f32 v11, v11, v11 row_ror:1 row_mask:0xf bank_mask:0xf
    v_cvt_pk_bf16_f32 v8, 0, v8
    v_cvt_pk_bf16_f32 v9, 0, v9
    v_cvt_pk_bf16_f32 v10, 0, v10
    v_cvt_pk_bf16_f32 v11, 0, v11
    v_mul_f32 v8, s13, v8
    v_mul_f32 v9, s13, v9
    v_mul_f32 v10, s13, v10
    v_mul_f32 v11, s13, v11
    v_cvt_pk_bf16_f32 v8, 0, v8
    v_cvt_pk_bf16_f32 v9, 0, v9
    v_cvt_pk_bf16_f32 v10, 0, v10
    v_cvt_pk_bf16_f32 v11, 0, v11
    v_max3_f32 v35, v8, v9, v32
    v_max_f32 v36, v10, v11
    v_max_f32 v35, v35, v36
    v_mul_f32 v34, s12, v35
    v_fma_f32 v36, v32, s12, -v34
    v_mov_b32 v32, v35
    v_exp_f32 v36, v36
    v_fma_f32 v8, v8, s12, -v34
    v_fma_f32 v9, v9, s12, -v34
    v_fma_f32 v10, v10, s12, -v34
    v_fma_f32 v11, v11, s12, -v34
    v_exp_f32 v8, v8
    v_exp_f32 v9, v9
    v_exp_f32 v10, v10
    v_exp_f32 v11, v11
    v_mul_f32 v24, v24, v36
    v_mul_f32 v25, v25, v36
    v_mul_f32 v26, v26, v36
    v_mul_f32 v27, v27, v36
    v_mul_f32 v28, v28, v36
    v_mul_f32 v29, v29, v36
    v_mul_f32 v30, v30, v36
    v_mul_f32 v31, v31, v36
    v_fma_f32 v33, v33, v36, v8
    v_add_f32 v35, v9, v10
    v_add_f32 v33, v33, v11
    v_add_f32 v33, v33, v35
    v_cvt_pk_bf16_f32 v36, v8, 0
    v_cvt_pk_bf16_f32 v8, 0, v8
    v_cvt_pk_bf16_f32 v37, v9, 0
    v_cvt_pk_bf16_f32 v9, 0, v9
    v_cvt_pk_bf16_f32 v38, v10, 0
    v_cvt_pk_bf16_f32 v10, 0, v10
    v_cvt_pk_bf16_f32 v39, v11, 0
    v_cvt_pk_bf16_f32 v11, 0, v11
    buffer_load_dwordx4 v[120:123], v1, s[48:51], s8 offen offset:0 nt
    buffer_load_dwordx4 v[124:127], v1, s[48:51], s8 offen offset:1024 nt
    buffer_load_dwordx4 v[128:131], v1, s[48:51], s8 offen offset:2048 nt
    buffer_load_dwordx4 v[132:135], v1, s[48:51], s8 offen offset:3072 nt
L_pv:
    s_waitcnt vmcnt(0)
    v_readfirstlane_b32 s6, v3
    s_bfe_u32 s88, s6, 0x30000
    s_lshl_b32 s88, s88, 14
    s_add_u32 s8, s95, s88
    s_bfe_u32 s88, s6, 0x20003
    s_lshl_b32 s88, s88, 21
    s_add_u32 s8, s8, s88
    s_bfe_u32 s88, s6, 0x20005
    s_lshl_b32 s88, s88, 12
    s_add_u32 s8, s8, s88
    s_bfe_u32 s88, s6, 0x40007
    s_lshl_b32 s88, s88, 17
    s_add_u32 s8, s8, s88
    s_and_b32 s8, s8, 0x7fffff
    s_cmp_ge_u32 s6, 1920
    s_cbranch_scc1 L_eager
L_norm:
    v_dot2_f32_bf16 v24, v120, v36, v24
    v_dot2_f32_bf16 v25, v120, v8, v25
    v_dot2_f32_bf16 v26, v121, v36, v26
    v_dot2_f32_bf16 v27, v121, v8, v27
    v_dot2_f32_bf16 v28, v122, v36, v28
    v_dot2_f32_bf16 v29, v122, v8, v29
    v_dot2_f32_bf16 v30, v123, v36, v30
    v_dot2_f32_bf16 v31, v123, v8, v31
    v_dot2_f32_bf16 v24, v124, v37, v24
    v_dot2_f32_bf16 v25, v124, v9, v25
    v_dot2_f32_bf16 v26, v125, v37, v26
    v_dot2_f32_bf16 v27, v125, v9, v27
    v_dot2_f32_bf16 v28, v126, v37, v28
    v_dot2_f32_bf16 v29, v126, v9, v29
    v_dot2_f32_bf16 v30, v127, v37, v30
    v_dot2_f32_bf16 v31, v127, v9, v31
    v_dot2_f32_bf16 v24, v128, v38, v24
    v_dot2_f32_bf16 v25, v128, v10, v25
    v_dot2_f32_bf16 v26, v129, v38, v26
    v_dot2_f32_bf16 v27, v129, v10, v27
    v_dot2_f32_bf16 v28, v130, v38, v28
    v_dot2_f32_bf16 v29, v130, v10, v29
    v_dot2_f32_bf16 v30, v131, v38, v30
    v_dot2_f32_bf16 v31, v131, v10, v31
    v_dot2_f32_bf16 v24, v132, v39, v24
    v_dot2_f32_bf16 v25, v132, v11, v25
    v_dot2_f32_bf16 v26, v133, v39, v26
    v_dot2_f32_bf16 v27, v133, v11, v27
    v_dot2_f32_bf16 v28, v134, v39, v28
    v_dot2_f32_bf16 v29, v134, v11, v29
    v_dot2_f32_bf16 v30, v135, v39, v30
    v_dot2_f32_bf16 v31, v135, v11, v31
    buffer_load_dwordx4 v[104:107], v1, s[44:47], s8 offen offset:0 nt
    buffer_load_dwordx4 v[108:111], v1, s[44:47], s8 offen offset:1024 nt
    buffer_load_dwordx4 v[112:115], v1, s[44:47], s8 offen offset:2048 nt
    buffer_load_dwordx4 v[116:119], v1, s[44:47], s8 offen offset:3072 nt
    s_branch L_loop
L_eager:
    s_cmp_ge_u32 s6, 2048
    s_cbranch_scc1 L_last
    v_mov_b32 v3, 1
    s_mov_b64 exec, 1
    buffer_atomic_add v3, off, s[52:55], s82 sc0 sc1
    s_mov_b64 exec, -1
    buffer_load_dwordx4 v[104:107], v1, s[44:47], s8 offen offset:0 nt
    buffer_load_dwordx4 v[108:111], v1, s[44:47], s8 offen offset:1024 nt
    buffer_load_dwordx4 v[112:115], v1, s[44:47], s8 offen offset:2048 nt
    buffer_load_dwordx4 v[116:119], v1, s[44:47], s8 offen offset:3072 nt
    v_dot2_f32_bf16 v24, v120, v36, v24
    v_dot2_f32_bf16 v25, v120, v8, v25
    v_dot2_f32_bf16 v26, v121, v36, v26
    v_dot2_f32_bf16 v27, v121, v8, v27
    v_dot2_f32_bf16 v28, v122, v36, v28
    v_dot2_f32_bf16 v29, v122, v8, v29
    v_dot2_f32_bf16 v30, v123, v36, v30
    v_dot2_f32_bf16 v31, v123, v8, v31
    v_dot2_f32_bf16 v24, v124, v37, v24
    v_dot2_f32_bf16 v25, v124, v9, v25
    v_dot2_f32_bf16 v26, v125, v37, v26
    v_dot2_f32_bf16 v27, v125, v9, v27
    v_dot2_f32_bf16 v28, v126, v37, v28
    v_dot2_f32_bf16 v29, v126, v9, v29
    v_dot2_f32_bf16 v30, v127, v37, v30
    v_dot2_f32_bf16 v31, v127, v9, v31
    v_dot2_f32_bf16 v24, v128, v38, v24
    v_dot2_f32_bf16 v25, v128, v10, v25
    v_dot2_f32_bf16 v26, v129, v38, v26
    v_dot2_f32_bf16 v27, v129, v10, v27
    v_dot2_f32_bf16 v28, v130, v38, v28
    v_dot2_f32_bf16 v29, v130, v10, v29
    v_dot2_f32_bf16 v30, v131, v38, v30
    v_dot2_f32_bf16 v31, v131, v10, v31
    v_dot2_f32_bf16 v24, v132, v39, v24
    v_dot2_f32_bf16 v25, v132, v11, v25
    v_dot2_f32_bf16 v26, v133, v39, v26
    v_dot2_f32_bf16 v27, v133, v11, v27
    v_dot2_f32_bf16 v28, v134, v39, v28
    v_dot2_f32_bf16 v29, v134, v11, v29
    v_dot2_f32_bf16 v30, v135, v39, v30
    v_dot2_f32_bf16 v31, v135, v11, v31
    buffer_load_dwordx4 v[120:123], v1, s[48:51], s8 offen offset:0 nt
    buffer_load_dwordx4 v[124:127], v1, s[48:51], s8 offen offset:1024 nt
    buffer_load_dwordx4 v[128:131], v1, s[48:51], s8 offen offset:2048 nt
    buffer_load_dwordx4 v[132:135], v1, s[48:51], s8 offen offset:3072 nt
L_eager_body:
    s_waitcnt vmcnt(4)
    v_dot2_f32_bf16 v8, v104, v4, 0
    v_dot2_f32_bf16 v9, v108, v4, 0
    v_dot2_f32_bf16 v10, v112, v4, 0
    v_dot2_f32_bf16 v11, v116, v4, 0
    v_dot2_f32_bf16 v8, v105, v5, v8
    v_dot2_f32_bf16 v9, v109, v5, v9
    v_dot2_f32_bf16 v10, v113, v5, v10
    v_dot2_f32_bf16 v11, v117, v5, v11
    v_dot2_f32_bf16 v8, v106, v6, v8
    v_dot2_f32_bf16 v9, v110, v6, v9
    v_dot2_f32_bf16 v10, v114, v6, v10
    v_dot2_f32_bf16 v11, v118, v6, v11
    v_dot2_f32_bf16 v8, v107, v7, v8
    v_dot2_f32_bf16 v9, v111, v7, v9
    v_dot2_f32_bf16 v10, v115, v7, v10
    v_dot2_f32_bf16 v11, v119, v7, v11
    s_nop 2
    v_add_f32 v8, v8, v8 row_ror:8 row_mask:0xf bank_mask:0xf
    v_add_f32 v9, v9, v9 row_ror:8 row_mask:0xf bank_mask:0xf
    v_add_f32 v10, v10, v10 row_ror:8 row_mask:0xf bank_mask:0xf
    v_add_f32 v11, v11, v11 row_ror:8 row_mask:0xf bank_mask:0xf
    v_add_f32 v8, v8, v8 row_ror:4 row_mask:0xf bank_mask:0xf
    v_add_f32 v9, v9, v9 row_ror:4 row_mask:0xf bank_mask:0xf
    v_add_f32 v10, v10, v10 row_ror:4 row_mask:0xf bank_mask:0xf
    v_add_f32 v11, v11, v11 row_ror:4 row_mask:0xf bank_mask:0xf
    v_add_f32 v8, v8, v8 row_ror:2 row_mask:0xf bank_mask:0xf
    v_add_f32 v9, v9, v9 row_ror:2 row_mask:0xf bank_mask:0xf
    v_add_f32 v10, v10, v10 row_ror:2 row_mask:0xf bank_mask:0xf
    v_add_f32 v11, v11, v11 row_ror:2 row_mask:0xf bank_mask:0xf
    v_add_f32 v8, v8, v8 row_ror:1 row_mask:0xf bank_mask:0xf
    v_add_f32 v9, v9, v9 row_ror:1 row_mask:0xf bank_mask:0xf
    v_add_f32 v10, v10, v10 row_ror:1 row_mask:0xf bank_mask:0xf
    v_add_f32 v11, v11, v11 row_ror:1 row_mask:0xf bank_mask:0xf
    v_cvt_pk_bf16_f32 v8, 0, v8
    v_cvt_pk_bf16_f32 v9, 0, v9
    v_cvt_pk_bf16_f32 v10, 0, v10
    v_cvt_pk_bf16_f32 v11, 0, v11
    v_mul_f32 v8, s13, v8
    v_mul_f32 v9, s13, v9
    v_mul_f32 v10, s13, v10
    v_mul_f32 v11, s13, v11
    v_cvt_pk_bf16_f32 v8, 0, v8
    v_cvt_pk_bf16_f32 v9, 0, v9
    v_cvt_pk_bf16_f32 v10, 0, v10
    v_cvt_pk_bf16_f32 v11, 0, v11
    v_max3_f32 v35, v8, v9, v32
    v_max_f32 v36, v10, v11
    v_max_f32 v35, v35, v36
    v_mul_f32 v34, s12, v35
    v_fma_f32 v36, v32, s12, -v34
    v_mov_b32 v32, v35
    v_exp_f32 v36, v36
    v_fma_f32 v8, v8, s12, -v34
    v_fma_f32 v9, v9, s12, -v34
    v_fma_f32 v10, v10, s12, -v34
    v_fma_f32 v11, v11, s12, -v34
    v_exp_f32 v8, v8
    v_exp_f32 v9, v9
    v_exp_f32 v10, v10
    v_exp_f32 v11, v11
    v_mul_f32 v24, v24, v36
    v_mul_f32 v25, v25, v36
    v_mul_f32 v26, v26, v36
    v_mul_f32 v27, v27, v36
    v_mul_f32 v28, v28, v36
    v_mul_f32 v29, v29, v36
    v_mul_f32 v30, v30, v36
    v_mul_f32 v31, v31, v36
    v_fma_f32 v33, v33, v36, v8
    v_add_f32 v35, v9, v10
    v_add_f32 v33, v33, v11
    v_add_f32 v33, v33, v35
    v_cvt_pk_bf16_f32 v36, v8, 0
    v_cvt_pk_bf16_f32 v8, 0, v8
    v_cvt_pk_bf16_f32 v37, v9, 0
    v_cvt_pk_bf16_f32 v9, 0, v9
    v_cvt_pk_bf16_f32 v38, v10, 0
    v_cvt_pk_bf16_f32 v10, 0, v10
    v_cvt_pk_bf16_f32 v39, v11, 0
    v_cvt_pk_bf16_f32 v11, 0, v11
    s_branch L_pv
L_last:
    v_dot2_f32_bf16 v24, v120, v36, v24
    v_dot2_f32_bf16 v25, v120, v8, v25
    v_dot2_f32_bf16 v26, v121, v36, v26
    v_dot2_f32_bf16 v27, v121, v8, v27
    v_dot2_f32_bf16 v28, v122, v36, v28
    v_dot2_f32_bf16 v29, v122, v8, v29
    v_dot2_f32_bf16 v30, v123, v36, v30
    v_dot2_f32_bf16 v31, v123, v8, v31
    v_dot2_f32_bf16 v24, v124, v37, v24
    v_dot2_f32_bf16 v25, v124, v9, v25
    v_dot2_f32_bf16 v26, v125, v37, v26
    v_dot2_f32_bf16 v27, v125, v9, v27
    v_dot2_f32_bf16 v28, v126, v37, v28
    v_dot2_f32_bf16 v29, v126, v9, v29
    v_dot2_f32_bf16 v30, v127, v37, v30
    v_dot2_f32_bf16 v31, v127, v9, v31
    v_dot2_f32_bf16 v24, v128, v38, v24
    v_dot2_f32_bf16 v25, v128, v10, v25
    v_dot2_f32_bf16 v26, v129, v38, v26
    v_dot2_f32_bf16 v27, v129, v10, v27
    v_dot2_f32_bf16 v28, v130, v38, v28
    v_dot2_f32_bf16 v29, v130, v10, v29
    v_dot2_f32_bf16 v30, v131, v38, v30
    v_dot2_f32_bf16 v31, v131, v10, v31
    v_dot2_f32_bf16 v24, v132, v39, v24
    v_dot2_f32_bf16 v25, v132, v11, v25
    v_dot2_f32_bf16 v26, v133, v39, v26
    v_dot2_f32_bf16 v27, v133, v11, v27
    v_dot2_f32_bf16 v28, v134, v39, v28
    v_dot2_f32_bf16 v29, v134, v11, v29
    v_dot2_f32_bf16 v30, v135, v39, v30
    v_dot2_f32_bf16 v31, v135, v11, v31
    v_mov_b32 v35, v32
    v_mov_b32 v37, v35
    s_nop 1
    v_permlane16_swap_b32 v35, v37
    s_nop 0
    v_max_f32 v35, v35, v37
    v_mov_b32 v37, v35
    s_nop 1
    v_permlane32_swap_b32 v35, v37
    s_nop 0
    v_max_f32 v35, v35, v37
    v_sub_f32 v36, v32, v35
    v_mul_f32 v36, s12, v36
    v_exp_f32 v36, v36
    v_mov_b32 v32, v35
    v_mul_f32 v33, v33, v36
    v_pk_mul_f32 v[24:25], v[36:37], v[24:25] op_sel_hi:[0,1]
    v_pk_mul_f32 v[26:27], v[36:37], v[26:27] op_sel_hi:[0,1]
    v_pk_mul_f32 v[28:29], v[36:37], v[28:29] op_sel_hi:[0,1]
    v_pk_mul_f32 v[30:31], v[36:37], v[30:31] op_sel_hi:[0,1]
    v_mov_b32 v37, v33
    s_nop 1
    v_permlane32_swap_b32 v24, v28
    v_permlane32_swap_b32 v25, v29
    v_permlane32_swap_b32 v26, v30
    v_permlane32_swap_b32 v27, v31
    v_permlane32_swap_b32 v33, v37
    v_pk_add_f32 v[24:25], v[24:25], v[28:29]
    v_pk_add_f32 v[26:27], v[26:27], v[30:31]
    v_add_f32 v33, v33, v37
    v_mov_b32 v37, v33
    s_nop 0
    v_permlane16_swap_b32 v24, v26
    v_permlane16_swap_b32 v25, v27
    v_permlane16_swap_b32 v33, v37
    v_pk_add_f32 v[24:25], v[24:25], v[26:27]
    v_add_f32 v33, v33, v37
    ds_write_b64 v97, v[24:25] offset:256
    ds_write_b64 v98, v[32:33] offset:4352
    s_waitcnt lgkmcnt(0)
    s_cbranch_execz L_sk1
    s_barrier
L_sk1:
    v_lshrrev_b32 v2, 2, v0
    v_and_b32 v3, 3, v0
    v_lshl_add_u32 v33, v3, 5, v99
    s_lshl_b32 s14, s81, 7
    v_add_u32 v33, s14, v33
    s_cmp_lt_u32 s2, 160
    s_cbranch_scc1 L_wo
    s_cmp_lt_u32 s2, 214
    s_cbranch_scc1 L_ff
    s_cbranch_execz L_dry1
    s_endpgm
L_wo:
    s_lshr_b32 s14, s81, 1
    s_lshl_b32 s15, s73, 2
    s_add_u32 s14, s14, s15
    s_mul_i32 s8, s14, 5120
    s_add_u32 s8, s8, 0x20000
    s_add_u32 s9, s8, 2560
    s_and_b32 s14, s81, 1
    s_lshl_b32 s14, s14, 8
    v_lshl_add_u32 v4, v0, 2, s14
    v_mov_b32 v24, 0
    v_mov_b32 v25, 0
    v_mov_b32 v26, 0
    v_mov_b32 v27, 0
    v_mov_b32 v28, 0
    v_mov_b32 v29, 0
    v_mov_b32 v30, 0
    v_mov_b32 v31, 0
    v_and_b32 v8, 7, v0
    v_mul_u32_u24 v8, 0x280, v8
    s_cbranch_execz L_sk2
    s_mov_b32 s7, 0
L_la:
    buffer_load_dwordx2 v[112:113], v8, s[52:55], s8 offen offset:512 sc1
    s_waitcnt vmcnt(0)
    v_cmp_eq_u32 vcc, -1, v112
    s_add_u32 s7, s7, 1
    s_cmp_ge_u32 s7, 131072
    s_cbranch_scc1 L_la_x
    s_and_b32 s76, vcc_lo, 0xff
    s_bcnt1_i32_b32 s76, s76
    s_cmp_le_u32 s76, 2
    s_cbranch_scc1 L_la_x
    s_sleep 4
    s_branch L_la
L_la_x:
L_sk2:
    s_mov_b32 s7, 0
L_pa:
    s_cbranch_execz L_sk3
    buffer_load_dwordx2 v[112:113], v8, s[52:55], s8 offen offset:512 sc1
    buffer_load_dword v104, v4, s[52:55], s8 offen offset:0 sc1
    buffer_load_dword v105, v4, s[52:55], s8 offen offset:640 sc1
    buffer_load_dword v106, v4, s[52:55], s8 offen offset:1280 sc1
    buffer_load_dword v107, v4, s[52:55], s8 offen offset:1920 sc1
    buffer_load_dword v108, v4, s[52:55], s9 offen offset:0 sc1
    buffer_load_dword v109, v4, s[52:55], s9 offen offset:640 sc1
    buffer_load_dword v110, v4, s[52:55], s9 offen offset:1280 sc1
    buffer_load_dword v111, v4, s[52:55], s9 offen offset:1920 sc1
L_sk3:
    s_waitcnt vmcnt(0)
    v_max_u32 v6, v104, v105
    v_max3_u32 v6, v6, v106, v107
    v_max3_u32 v6, v6, v108, v109
    v_max3_u32 v6, v6, v110, v111
    v_max3_u32 v6, v6, v112, v113
    v_cmp_eq_u32 vcc, -1, v6
    s_add_u32 s7, s7, 1
    s_cmp_ge_u32 s7, 131072
    s_cbranch_scc1 L_pa_x
    s_cbranch_vccnz L_pa
L_pa_x:
    v_max_f32 v6, v112, v112 row_ror:4 row_mask:0xf bank_mask:0xf
    s_nop 1
    v_max_f32 v6, v6, v6 row_ror:2 row_mask:0xf bank_mask:0xf
    s_nop 1
    v_max_f32 v6, v6, v6 row_ror:1 row_mask:0xf bank_mask:0xf
    v_sub_f32 v112, v112, v6
    v_mul_f32 v112, s12, v112
    v_exp_f32 v112, v112
    s_nop 0
    v_mul_f32 v6, v112, v113
    v_mul_f32 v7, v112, v104 row_newbcast:0 row_mask:0xf bank_mask:0xf
    v_mul_f32 v9, v112, v105 row_newbcast:1 row_mask:0xf bank_mask:0xf
    v_add_f32 v6, v6, v6 row_ror:4 row_mask:0xf bank_mask:0xf
    v_fmac_f32 v7, v112, v106 row_newbcast:2 row_mask:0xf bank_mask:0xf
    v_fmac_f32 v9, v112, v107 row_newbcast:3 row_mask:0xf bank_mask:0xf
    v_add_f32 v6, v6, v6 row_ror:2 row_mask:0xf bank_mask:0xf
    v_fmac_f32 v7, v112, v108 row_newbcast:4 row_mask:0xf bank_mask:0xf
    v_fmac_f32 v9, v112, v109 row_newbcast:5 row_mask:0xf bank_mask:0xf
    v_add_f32 v6, v6, v6 row_ror:1 row_mask:0xf bank_mask:0xf
    v_fmac_f32 v7, v112, v110 row_newbcast:6 row_mask:0xf bank_mask:0xf
    v_fmac_f32 v9, v112, v111 row_newbcast:7 row_mask:0xf bank_mask:0xf
    v_rcp_f32 v6, v6
    v_add_f32 v7, v7, v9
    v_mul_f32 v7, v7, v6
    s_nop 1
    v_mov_b32 v9, v7 quad_perm:[1,1,3,3] row_mask:0xf bank_mask:0xf
    v_cvt_pk_bf16_f32 v7, v7, v9
    s_nop 1
    v_dot2c_f32_bf16 v24, v7, v40 quad_perm:[0,0,0,0] row_mask:0xf bank_mask:0xf
    v_dot2c_f32_bf16 v25, v7, v44 quad_perm:[0,0,0,0] row_mask:0xf bank_mask:0xf
    v_dot2c_f32_bf16 v26, v7, v41 quad_perm:[0,0,0,0] row_mask:0xf bank_mask:0xf
    v_dot2c_f32_bf16 v27, v7, v45 quad_perm:[0,0,0,0] row_mask:0xf bank_mask:0xf
    v_dot2c_f32_bf16 v28, v7, v42 quad_perm:[0,0,0,0] row_mask:0xf bank_mask:0xf
    v_dot2c_f32_bf16 v29, v7, v46 quad_perm:[0,0,0,0] row_mask:0xf bank_mask:0xf
    v_dot2c_f32_bf16 v30, v7, v43 quad_perm:[0,0,0,0] row_mask:0xf bank_mask:0xf
    v_dot2c_f32_bf16 v31, v7, v47 quad_perm:[0,0,0,0] row_mask:0xf bank_mask:0xf
    v_dot2c_f32_bf16 v24, v7, v48 quad_perm:[2,2,2,2] row_mask:0xf bank_mask:0xf
    v_dot2c_f32_bf16 v25, v7, v52 quad_perm:[2,2,2,2] row_mask:0xf bank_mask:0xf
    v_dot2c_f32_bf16 v26, v7, v49 quad_perm:[2,2,2,2] row_mask:0xf bank_mask:0xf
    v_dot2c_f32_bf16 v27, v7, v53 quad_perm:[2,2,2,2] row_mask:0xf bank_mask:0xf
    v_dot2c_f32_bf16 v28, v7, v50 quad_perm:[2,2,2,2] row_mask:0xf bank_mask:0xf
    v_dot2c_f32_bf16 v29, v7, v54 quad_perm:[2,2,2,2] row_mask:0xf bank_mask:0xf
    v_dot2c_f32_bf16 v30, v7, v51 quad_perm:[2,2,2,2] row_mask:0xf bank_mask:0xf
    v_dot2c_f32_bf16 v31, v7, v55 quad_perm:[2,2,2,2] row_mask:0xf bank_mask:0xf
    s_nop 2
    v_permlane32_swap_b32 v24, v28
    v_permlane32_swap_b32 v25, v29
    v_permlane32_swap_b32 v26, v30
    v_permlane32_swap_b32 v27, v31
    s_nop 0
    v_pk_add_f32 v[24:25], v[24:25], v[28:29]
    v_pk_add_f32 v[26:27], v[26:27], v[30:31]
    s_nop 1
    v_permlane16_swap_b32 v24, v26
    v_permlane16_swap_b32 v25, v27
    s_nop 0
    v_pk_add_f32 v[24:25], v[24:25], v[26:27]
    s_nop 1
    v_add_f32 v24, v24, v24 row_ror:8 row_mask:0xf bank_mask:0xf
    v_add_f32 v25, v25, v25 row_ror:8 row_mask:0xf bank_mask:0xf
    s_nop 1
    v_add_f32 v24, v24, v24 row_ror:4 row_mask:0xf bank_mask:0xf
    v_add_f32 v25, v25, v25 row_ror:4 row_mask:0xf bank_mask:0xf
    ds_write_b64 v33, v[24:25] offset:7040
    s_waitcnt lgkmcnt(0)
    s_cbranch_execz L_sk4
    s_barrier
L_sk4:
    s_cmp_lg_u32 s81, 0
    s_cbranch_scc1 L_end
    v_lshlrev_b32 v4, 2, v0
    s_mov_b32 exec_hi, 0
    ds_read_b32 v8, v4 offset:7040
    ds_read_b32 v9, v4 offset:7168
    ds_read_b32 v10, v4 offset:7296
    ds_read_b32 v11, v4 offset:7424
    ds_read_b32 v12, v4 offset:7552
    ds_read_b32 v13, v4 offset:7680
    ds_read_b32 v14, v4 offset:7808
    ds_read_b32 v15, v4 offset:7936
    s_mul_i32 s14, s73, 2560
    s_lshl_b32 s15, s74, 7
    s_add_u32 s14, s14, s15
    s_add_u32 s14, s14, 0x48000
    s_waitcnt lgkmcnt(0)
    v_add_f32 v8, v8, v9
    v_add_f32 v10, v10, v11
    v_add_f32 v12, v12, v13
    v_add_f32 v14, v14, v15
    v_add_f32 v8, v8, v10
    v_add_f32 v12, v12, v14
    v_add_f32 v8, v8, v12
    v_min_u32 v8, -2, v8
    s_cbranch_execz L_sk5
    buffer_store_dword v8, v4, s[52:55], s14 offen sc1
L_sk5:
    s_cbranch_execz L_dry1
    s_endpgm
L_ff:
    s_cmp_ge_u32 s81, 5
    s_cbranch_scc1 L_ff1
    s_lshl_b32 s14, s81, 9
    v_lshl_add_u32 v4, v0, 3, s14
    s_mov_b32 s8, 0x48000
    s_mov_b32 s9, 0x49400
    s_mov_b32 s10, 0x4a800
    s_mov_b32 s11, 0x4bc00
    v_and_b32 v5, 7, v0
    v_mul_u32_u24 v5, 0xa00, v5
    v_add_u32 v5, s14, v5
    s_cbranch_execz L_sk6
    s_mov_b32 s7, 0
L_lb:
    buffer_load_dword v104, v5, s[52:55], s8 offen sc1
    s_waitcnt vmcnt(0)
    v_cmp_eq_u32 vcc, -1, v104
    s_add_u32 s7, s7, 1
    s_cmp_ge_u32 s7, 131072
    s_cbranch_scc1 L_lb_x
    s_and_b32 s76, vcc_lo, 0xff
    s_bcnt1_i32_b32 s76, s76
    s_cmp_le_u32 s76, 7
    s_cbranch_scc1 L_lb_x
    s_sleep 4
    s_branch L_lb
L_lb_x:
L_sk6:
    s_mov_b32 s7, 0
L_pb:
    s_cbranch_execz L_sk7
    buffer_load_dwordx2 v[104:105], v4, s[52:55], s8 offen offset:0 sc1
    buffer_load_dwordx2 v[106:107], v4, s[52:55], s8 offen offset:2560 sc1
    buffer_load_dwordx2 v[108:109], v4, s[52:55], s9 offen offset:0 sc1
    buffer_load_dwordx2 v[110:111], v4, s[52:55], s9 offen offset:2560 sc1
    buffer_load_dwordx2 v[112:113], v4, s[52:55], s10 offen offset:0 sc1
    buffer_load_dwordx2 v[114:115], v4, s[52:55], s10 offen offset:2560 sc1
    buffer_load_dwordx2 v[116:117], v4, s[52:55], s11 offen offset:0 sc1
    buffer_load_dwordx2 v[118:119], v4, s[52:55], s11 offen offset:2560 sc1
L_sk7:
    s_waitcnt vmcnt(0)
    v_max_u32 v6, v104, v105
    v_max3_u32 v6, v6, v106, v107
    v_max3_u32 v6, v6, v108, v109
    v_max3_u32 v6, v6, v110, v111
    v_max3_u32 v6, v6, v112, v113
    v_max3_u32 v6, v6, v114, v115
    v_max3_u32 v6, v6, v116, v117
    v_max3_u32 v6, v6, v118, v119
    v_cmp_eq_u32 vcc, -1, v6
    s_add_u32 s7, s7, 1
    s_cmp_ge_u32 s7, 131072
    s_cbranch_scc1 L_pb_x
    s_cbranch_vccnz L_pb
L_pb_x:
    v_pk_add_f32 v[104:105], v[104:105], v[106:107]
    v_pk_add_f32 v[108:109], v[108:109], v[110:111]
    v_pk_add_f32 v[112:113], v[112:113], v[114:115]
    v_pk_add_f32 v[116:117], v[116:117], v[118:119]
    v_pk_add_f32 v[104:105], v[104:105], v[108:109]
    v_pk_add_f32 v[112:113], v[112:113], v[116:117]
    v_pk_add_f32 v[104:105], v[104:105], v[112:113]
    v_cvt_pk_bf16_f32 v104, 0, v104
    v_cvt_pk_bf16_f32 v105, 0, v105
    v_lshlrev_b32 v6, 16, v92
    v_and_b32 v7, s72, v92
    v_add_f32 v104, v104, v6
    v_add_f32 v105, v105, v7
    v_cvt_pk_bf16_f32 v104, 0, v104
    v_cvt_pk_bf16_f32 v105, 0, v105
    v_readfirstlane_b32 s76, v104
    ds_write_b64 v4, v[104:105] offset:4480
    s_lshl_b32 s14, s81, 3
    v_mov_b32 v10, s14
    v_subrev_f32 v6, s76, v104
    v_subrev_f32 v7, s76, v105
    v_mul_f32 v9, v6, v6
    v_add_f32 v8, v6, v7
    v_fmac_f32 v9, v7, v7
    s_nop 0
    v_add_f32 v8, v8, v8 row_ror:8 row_mask:0xf bank_mask:0xf
    v_add_f32 v9, v9, v9 row_ror:8 row_mask:0xf bank_mask:0xf
    s_nop 0
    v_add_f32 v8, v8, v8 row_ror:4 row_mask:0xf bank_mask:0xf
    v_add_f32 v9, v9, v9 row_ror:4 row_mask:0xf bank_mask:0xf
    s_nop 0
    v_add_f32 v8, v8, v8 row_ror:2 row_mask:0xf bank_mask:0xf
    v_add_f32 v9, v9, v9 row_ror:2 row_mask:0xf bank_mask:0xf
    s_nop 0
    v_add_f32 v8, v8, v8 row_ror:1 row_mask:0xf bank_mask:0xf
    v_add_f32 v9, v9, v9 row_ror:1 row_mask:0xf bank_mask:0xf
    s_nop 1
    v_permlane16_swap_b32 v8, v9
    s_nop 0
    v_add_f32 v8, v8, v9
    v_mov_b32 v9, v8
    s_nop 1
    v_permlane32_swap_b32 v8, v9
    s_nop 0
    v_add_f32 v8, v8, v9
    v_mov_b32 v9, v8
    s_nop 1
    v_permlane16_swap_b32 v8, v9
    s_nop 0
    v_mul_f32 v6, 0x3c000000, v8
    v_fma_f32 v9, -v6, v8, v9
    v_add_f32 v8, s76, v6
    ds_write_b64 v10, v[8:9] offset:8064
L_ff1:
    v_mov_b32 v4, 0
    s_mul_i32 s14, s81, 320
    v_lshl_add_u32 v5, v2, 2, s14
    s_waitcnt lgkmcnt(0)
    s_cbranch_execz L_sk8
    s_barrier
L_sk8:
    ds_read_b128 v[104:107], v4 offset:8064
    ds_read_b128 v[108:111], v4 offset:8080
    ds_read_b64 v[112:113], v4 offset:8096
    ds_read_b32 v114, v5 offset:4480
    ds_read_b32 v115, v5 offset:4544
    ds_read_b32 v116, v5 offset:4608
    ds_read_b32 v117, v5 offset:4672
    ds_read_b32 v118, v5 offset:4736
    v_mov_b32 v24, 0
    v_mov_b32 v25, 0
    v_mov_b32 v26, 0
    v_mov_b32 v27, 0
    v_mov_b32 v28, 0
    v_mov_b32 v29, 0
    v_mov_b32 v30, 0
    v_mov_b32 v31, 0
    s_waitcnt lgkmcnt(5)
    v_add_f32 v6, v104, v106
    v_add_f32 v7, v108, v110
    v_add_f32 v8, v105, v107
    v_add_f32 v6, v6, v112
    v_add_f32 v9, v109, v111
    v_add_f32 v6, v6, v7
    v_add_f32 v8, v8, v113
    v_mul_f32 v6, 0x3e4ccccd, v6
    v_add_f32 v8, v8, v9
    v_sub_f32 v104, v104, v6
    v_sub_f32 v106, v106, v6
    v_sub_f32 v108, v108, v6
    v_sub_f32 v110, v110, v6
    v_sub_f32 v112, v112, v6
    v_mul_f32 v7, v104, v104
    v_mul_f32 v9, v106, v106
    v_fmac_f32 v7, v108, v108
    v_fmac_f32 v9, v110, v110
    v_fmac_f32 v7, v112, v112
    v_add_f32 v7, v7, v9
    v_fmac_f32 v8, 0x43000000, v7
    v_mul_f32 v8, 0x3acccccd, v8
    v_cvt_pk_bf16_f32 v6, 0, v6
    v_cvt_pk_bf16_f32 v8, 0, v8
    v_add_f32 v8, 0x3727c5ac, v8
    v_cvt_pk_bf16_f32 v8, 0, v8
    v_sqrt_f32 v8, v8
    s_nop 0
    v_cvt_pk_bf16_f32 v8, 0, v8
    v_rcp_f32 v7, v8
    s_nop 0
    s_waitcnt lgkmcnt(0)
    v_sub_f32 v114, v114, v6
    v_sub_f32 v115, v115, v6
    v_sub_f32 v116, v116, v6
    v_sub_f32 v117, v117, v6
    v_sub_f32 v118, v118, v6
    v_cvt_pk_bf16_f32 v114, 0, v114
    v_cvt_pk_bf16_f32 v115, 0, v115
    v_cvt_pk_bf16_f32 v116, 0, v116
    v_cvt_pk_bf16_f32 v117, 0, v117
    v_cvt_pk_bf16_f32 v118, 0, v118
    v_mul_f32 v114, v114, v7
    v_mul_f32 v115, v115, v7
    v_mul_f32 v116, v116, v7
    v_mul_f32 v117, v117, v7
    v_mul_f32 v118, v118, v7
    v_cvt_pk_bf16_f32 v120, v114, v115
    v_cvt_pk_bf16_f32 v121, v116, v117
    v_cvt_pk_bf16_f32 v122, v118, 0
    v_cvt_pk_bf16_f32 v123, 0, v118
    v_dot2c_f32_bf16 v24, v120, v40
    v_dot2c_f32_bf16 v25, v120, v44
    v_dot2c_f32_bf16 v26, v120, v41
    v_dot2c_f32_bf16 v27, v120, v45
    v_dot2c_f32_bf16 v28, v120, v42
    v_dot2c_f32_bf16 v29, v120, v46
    v_dot2c_f32_bf16 v30, v120, v43
    v_dot2c_f32_bf16 v31, v120, v47
    v_dot2c_f32_bf16 v24, v121, v48
    v_dot2c_f32_bf16 v25, v121, v52
    v_dot2c_f32_bf16 v26, v121, v49
    v_dot2c_f32_bf16 v27, v121, v53
    v_dot2c_f32_bf16 v28, v121, v50
    v_dot2c_f32_bf16 v29, v121, v54
    v_dot2c_f32_bf16 v30, v121, v51
    v_dot2c_f32_bf16 v31, v121, v55
    v_dot2c_f32_bf16 v24, v122, v56
    v_dot2c_f32_bf16 v25, v123, v56
    v_dot2c_f32_bf16 v26, v122, v57
    v_dot2c_f32_bf16 v27, v123, v57
    v_dot2c_f32_bf16 v28, v122, v58
    v_dot2c_f32_bf16 v29, v123, v58
    v_dot2c_f32_bf16 v30, v122, v59
    v_dot2c_f32_bf16 v31, v123, v59
    v_and_b32 v4, 7, v0
    v_and_b32 v5, 48, v0
    v_lshlrev_b32 v5, 1, v5
    v_lshl_add_u32 v4, v4, 2, v5
    v_and_b32 v5, 8, v0
    v_lshl_add_u32 v4, v5, 6, v4
    s_nop 2
    v_permlane32_swap_b32 v24, v28
    v_permlane32_swap_b32 v25, v29
    v_permlane32_swap_b32 v26, v30
    v_permlane32_swap_b32 v27, v31
    s_nop 0
    v_pk_add_f32 v[24:25], v[24:25], v[28:29]
    v_pk_add_f32 v[26:27], v[26:27], v[30:31]
    s_nop 1
    v_permlane16_swap_b32 v24, v26
    v_permlane16_swap_b32 v25, v27
    s_nop 0
    v_pk_add_f32 v[24:25], v[24:25], v[26:27]
    s_nop 1
    v_add_f32 v24, v24, v24 row_ror:8 row_mask:0xf bank_mask:0xf
    v_add_f32 v25, v25, v25 row_ror:8 row_mask:0xf bank_mask:0xf
    s_nop 1
    v_add_f32 v24, v24, v24 row_ror:4 row_mask:0xf bank_mask:0xf
    v_add_f32 v25, v25, v25 row_ror:4 row_mask:0xf bank_mask:0xf
    ds_write_b64 v33, v[24:25] offset:7040
    s_waitcnt lgkmcnt(0)
    s_cbranch_execz L_sk9
    s_barrier
L_sk9:
    s_cmp_ge_u32 s81, 5
    s_cbranch_scc1 L_end
    ds_read_b32 v8, v4 offset:7040
    ds_read_b32 v9, v4 offset:7168
    ds_read_b32 v10, v4 offset:7296
    ds_read_b32 v11, v4 offset:7424
    v_lshlrev_b32 v93, 16, v93
    v_mov_b32 v24, 0
    v_mov_b32 v25, 0
    v_mov_b32 v26, 0
    v_mov_b32 v27, 0
    v_mov_b32 v28, 0
    v_mov_b32 v29, 0
    v_mov_b32 v30, 0
    v_mov_b32 v31, 0
    s_mul_i32 s14, s73, 2560
    s_lshl_b32 s15, s81, 9
    s_add_u32 s14, s14, s15
    s_add_u32 s14, s14, 0x4d000
    s_waitcnt lgkmcnt(0)
    v_add_f32 v8, v8, v9
    v_add_f32 v10, v10, v11
    v_add_f32 v8, v8, v10
    s_nop 1
    v_add_f32 v8, v8, v8 row_ror:8 row_mask:0xf bank_mask:0xf
    v_cvt_pk_bf16_f32 v8, 0, v8
    v_add_f32 v8, v8, v93
    v_cvt_pk_bf16_f32 v8, 0, v8
    v_mul_f32 v9, v8, v8
    v_mul_f32 v9, 0x3d372713, v9
    v_fma_f32 v9, v9, v8, v8
    v_mul_f32 v9, 0xc0135761, v9
    v_exp_f32 v9, v9
    s_nop 0
    v_add_f32 v9, 1.0, v9
    v_rcp_f32 v9, v9
    s_nop 0
    v_mul_f32 v8, v8, v9
    s_nop 1
    v_mov_b32 v9, v8 quad_perm:[1,1,3,3] row_mask:0xf bank_mask:0xf
    v_cvt_pk_bf16_f32 v8, v8, v9
    s_nop 1
    v_dot2c_f32_bf16 v24, v8, v60 row_newbcast:0 row_mask:0xf bank_mask:0xf
    v_dot2c_f32_bf16 v25, v8, v64 row_newbcast:0 row_mask:0xf bank_mask:0xf
    v_dot2c_f32_bf16 v26, v8, v61 row_newbcast:0 row_mask:0xf bank_mask:0xf
    v_dot2c_f32_bf16 v27, v8, v65 row_newbcast:0 row_mask:0xf bank_mask:0xf
    v_dot2c_f32_bf16 v28, v8, v62 row_newbcast:0 row_mask:0xf bank_mask:0xf
    v_dot2c_f32_bf16 v29, v8, v66 row_newbcast:0 row_mask:0xf bank_mask:0xf
    v_dot2c_f32_bf16 v30, v8, v63 row_newbcast:0 row_mask:0xf bank_mask:0xf
    v_dot2c_f32_bf16 v31, v8, v67 row_newbcast:0 row_mask:0xf bank_mask:0xf
    v_dot2c_f32_bf16 v24, v8, v68 row_newbcast:2 row_mask:0xf bank_mask:0xf
    v_dot2c_f32_bf16 v25, v8, v72 row_newbcast:2 row_mask:0xf bank_mask:0xf
    v_dot2c_f32_bf16 v26, v8, v69 row_newbcast:2 row_mask:0xf bank_mask:0xf
    v_dot2c_f32_bf16 v27, v8, v73 row_newbcast:2 row_mask:0xf bank_mask:0xf
    v_dot2c_f32_bf16 v28, v8, v70 row_newbcast:2 row_mask:0xf bank_mask:0xf
    v_dot2c_f32_bf16 v29, v8, v74 row_newbcast:2 row_mask:0xf bank_mask:0xf
    v_dot2c_f32_bf16 v30, v8, v71 row_newbcast:2 row_mask:0xf bank_mask:0xf
    v_dot2c_f32_bf16 v31, v8, v75 row_newbcast:2 row_mask:0xf bank_mask:0xf
    v_dot2c_f32_bf16 v24, v8, v76 row_newbcast:4 row_mask:0xf bank_mask:0xf
    v_dot2c_f32_bf16 v25, v8, v80 row_newbcast:4 row_mask:0xf bank_mask:0xf
    v_dot2c_f32_bf16 v26, v8, v77 row_newbcast:4 row_mask:0xf bank_mask:0xf
    v_dot2c_f32_bf16 v27, v8, v81 row_newbcast:4 row_mask:0xf bank_mask:0xf
    v_dot2c_f32_bf16 v28, v8, v78 row_newbcast:4 row_mask:0xf bank_mask:0xf
    v_dot2c_f32_bf16 v29, v8, v82 row_newbcast:4 row_mask:0xf bank_mask:0xf
    v_dot2c_f32_bf16 v30, v8, v79 row_newbcast:4 row_mask:0xf bank_mask:0xf
    v_dot2c_f32_bf16 v31, v8, v83 row_newbcast:4 row_mask:0xf bank_mask:0xf
    v_dot2c_f32_bf16 v24, v8, v84 row_newbcast:6 row_mask:0xf bank_mask:0xf
    v_dot2c_f32_bf16 v25, v8, v88 row_newbcast:6 row_mask:0xf bank_mask:0xf
    v_dot2c_f32_bf16 v26, v8, v85 row_newbcast:6 row_mask:0xf bank_mask:0xf
    v_dot2c_f32_bf16 v27, v8, v89 row_newbcast:6 row_mask:0xf bank_mask:0xf
    v_dot2c_f32_bf16 v28, v8, v86 row_newbcast:6 row_mask:0xf bank_mask:0xf
    v_dot2c_f32_bf16 v29, v8, v90 row_newbcast:6 row_mask:0xf bank_mask:0xf
    v_dot2c_f32_bf16 v30, v8, v87 row_newbcast:6 row_mask:0xf bank_mask:0xf
    v_dot2c_f32_bf16 v31, v8, v91 row_newbcast:6 row_mask:0xf bank_mask:0xf
    s_nop 2
    v_permlane32_swap_b32 v24, v28
    v_permlane32_swap_b32 v25, v29
    v_permlane32_swap_b32 v26, v30
    v_permlane32_swap_b32 v27, v31
    s_nop 0
    v_pk_add_f32 v[24:25], v[24:25], v[28:29]
    v_pk_add_f32 v[26:27], v[26:27], v[30:31]
    s_nop 1
    v_permlane16_swap_b32 v24, v26
    v_permlane16_swap_b32 v25, v27
    s_nop 0
    v_pk_add_f32 v[24:25], v[24:25], v[26:27]
    v_min_u32 v24, -2, v24
    v_min_u32 v25, -2, v25
    s_cbranch_execz L_sk10
    buffer_store_dwordx2 v[24:25], v96, s[52:55], s14 offen sc1
L_sk10:
    s_cbranch_execz L_dry1
    s_endpgm
L_helper:
    s_setprio 3
    s_mov_b32 s56, s16
    s_and_b32 s57, s17, 0xffff
    s_mov_b32 s58, 0x500
    s_mov_b32 s59, 0x20000
    s_mov_b32 s60, s22
    s_and_b32 s61, s23, 0xffff
    s_mov_b32 s62, 0x500000
    s_mov_b32 s63, 0x20000
    s_mov_b32 s68, s38
    s_and_b32 s69, s39, 0xffff
    s_mov_b32 s70, 0x100
    s_mov_b32 s71, 0x20000
    v_lshlrev_b32 v1, 2, v0
    v_lshrrev_b32 v35, 4, v0
    v_and_b32 v34, 15, v0
    s_mul_i32 s14, s4, 655360
    s_lshl_b32 s15, s3, 8
    s_add_u32 s14, s14, s15
    v_mul_u32_u24 v5, 0x28000, v35
    v_lshl_add_u32 v5, v34, 4, v5
    s_mul_i32 s15, s4, 160
    v_mul_u32_u24 v4, 40, v35
    buffer_load_dword v8, v1, s[56:59], 0 offen offset:0
    buffer_load_dword v9, v1, s[56:59], 0 offen offset:256
    buffer_load_dword v10, v1, s[56:59], 0 offen offset:512
    buffer_load_dword v11, v1, s[56:59], 0 offen offset:768
    buffer_load_dword v12, v1, s[56:59], 0 offen offset:1024
    buffer_load_dwordx4 v[16:19], v4, s[56:59], s15 offen
    buffer_load_dwordx4 v[20:23], v4, s[56:59], s15 offen offset:16
    buffer_load_dwordx2 v[24:25], v4, s[56:59], s15 offen offset:32
    buffer_load_dwordx4 v[40:43], v5, s[60:63], s14 offen nt
    s_add_u32 s14, s14, 0x2000
    buffer_load_dwordx4 v[44:47], v5, s[60:63], s14 offen nt
    s_add_u32 s14, s14, 0x2000
    buffer_load_dwordx4 v[48:51], v5, s[60:63], s14 offen nt
    s_add_u32 s14, s14, 0x2000
    buffer_load_dwordx4 v[52:55], v5, s[60:63], s14 offen nt
    s_add_u32 s14, s14, 0x2000
    buffer_load_dwordx4 v[56:59], v5, s[60:63], s14 offen nt
    s_add_u32 s14, s14, 0x2000
    buffer_load_dwordx4 v[60:63], v5, s[60:63], s14 offen nt
    s_add_u32 s14, s14, 0x2000
    buffer_load_dwordx4 v[64:67], v5, s[60:63], s14 offen nt
    s_add_u32 s14, s14, 0x2000
    buffer_load_dwordx4 v[68:71], v5, s[60:63], s14 offen nt
    s_add_u32 s14, s14, 0x2000
    buffer_load_dwordx4 v[72:75], v5, s[60:63], s14 offen nt
    s_add_u32 s14, s14, 0x2000
    buffer_load_dwordx4 v[76:79], v5, s[60:63], s14 offen nt
    s_add_u32 s14, s14, 0x2000
    buffer_load_dwordx4 v[80:83], v5, s[60:63], s14 offen nt
    s_add_u32 s14, s14, 0x2000
    buffer_load_dwordx4 v[84:87], v5, s[60:63], s14 offen nt
    s_add_u32 s14, s14, 0x2000
    buffer_load_dwordx4 v[88:91], v5, s[60:63], s14 offen nt
    s_add_u32 s14, s14, 0x2000
    buffer_load_dwordx4 v[92:95], v5, s[60:63], s14 offen nt
    s_add_u32 s14, s14, 0x2000
    buffer_load_dwordx4 v[96:99], v5, s[60:63], s14 offen nt
    s_add_u32 s14, s14, 0x2000
    buffer_load_dwordx4 v[100:103], v5, s[60:63], s14 offen nt
    s_add_u32 s14, s14, 0x2000
    buffer_load_dwordx4 v[104:107], v5, s[60:63], s14 offen nt
    s_add_u32 s14, s14, 0x2000
    buffer_load_dwordx4 v[108:111], v5, s[60:63], s14 offen nt
    s_add_u32 s14, s14, 0x2000
    buffer_load_dwordx4 v[112:115], v5, s[60:63], s14 offen nt
    s_add_u32 s14, s14, 0x2000
    buffer_load_dwordx4 v[116:119], v5, s[60:63], s14 offen nt
    v_mov_b32 v28, -1
    v_mov_b32 v29, -1
    v_mov_b32 v30, -1
    v_mov_b32 v31, -1
    s_mul_i32 s14, s2, 1280
    s_add_u32 s14, s14, 0x20000
    v_lshlrev_b32 v6, 4, v0
    buffer_store_dwordx4 v[28:31], v6, s[52:55], s14 offen sc1
    buffer_store_dword v28, v1, s[52:55], s14 offen offset:1024 sc1
    buffer_load_dword v14, off, s[52:55], 0 offset:0 sc1
    s_mul_i32 s82, s3, 256
    s_add_u32 s82, s82, 0x10000
    v_add_u32 v15, 0xc0, v0
    s_cmp_eq_u32 s4, 0
    s_cselect_b32 s14, 0, 0x40000000
    v_lshl_add_u32 v26, v0, 8, s14
    s_mov_b64 exec, 0x1
    buffer_store_dword v15, v26, s[52:55], s82 offen sc1
    s_mov_b64 exec, -1
    v_mov_b32 v27, 0
    ds_write_b32 v27, v27 offset:8320
    s_waitcnt lgkmcnt(0)
    s_barrier
    s_waitcnt vmcnt(24)
    v_lshlrev_b32 v120, 16, v8
    v_and_b32 v121, s72, v8
    v_lshlrev_b32 v122, 16, v9
    v_and_b32 v123, s72, v9
    v_lshlrev_b32 v124, 16, v10
    v_and_b32 v125, s72, v10
    v_lshlrev_b32 v126, 16, v11
    v_and_b32 v127, s72, v11
    v_lshlrev_b32 v128, 16, v12
    v_and_b32 v129, s72, v12
    v_add_f32 v6, v120, v121
    v_add_f32 v6, v6, v122
    v_add_f32 v6, v6, v123
    v_add_f32 v6, v6, v124
    v_add_f32 v6, v6, v125
    v_add_f32 v6, v6, v126
    v_add_f32 v6, v6, v127
    v_add_f32 v6, v6, v128
    v_add_f32 v6, v6, v129
    s_nop 1
    v_add_f32 v6, v6, v6 row_ror:8 row_mask:0xf bank_mask:0xf
    s_nop 1
    v_add_f32 v6, v6, v6 row_ror:4 row_mask:0xf bank_mask:0xf
    s_nop 1
    v_add_f32 v6, v6, v6 row_ror:2 row_mask:0xf bank_mask:0xf
    s_nop 1
    v_add_f32 v6, v6, v6 row_ror:1 row_mask:0xf bank_mask:0xf
    v_mov_b32 v7, v6
    s_nop 1
    v_permlane16_swap_b32 v6, v7
    s_nop 0
    v_add_f32 v6, v6, v7
    v_mov_b32 v7, v6
    s_nop 1
    v_permlane32_swap_b32 v6, v7
    s_nop 0
    v_add_f32 v6, v6, v7
    v_mul_f32 v6, 0x3acccccd, v6
    v_sub_f32 v120, v120, v6
    v_sub_f32 v121, v121, v6
    v_sub_f32 v122, v122, v6
    v_sub_f32 v123, v123, v6
    v_sub_f32 v124, v124, v6
    v_sub_f32 v125, v125, v6
    v_sub_f32 v126, v126, v6
    v_sub_f32 v127, v127, v6
    v_sub_f32 v128, v128, v6
    v_sub_f32 v129, v129, v6
    v_mul_f32 v13, v120, v120
    v_fmac_f32 v13, v121, v121
    v_fmac_f32 v13, v122, v122
    v_fmac_f32 v13, v123, v123
    v_fmac_f32 v13, v124, v124
    v_fmac_f32 v13, v125, v125
    v_fmac_f32 v13, v126, v126
    v_fmac_f32 v13, v127, v127
    v_fmac_f32 v13, v128, v128
    v_fmac_f32 v13, v129, v129
    s_nop 1
    v_add_f32 v13, v13, v13 row_ror:8 row_mask:0xf bank_mask:0xf
    s_nop 1
    v_add_f32 v13, v13, v13 row_ror:4 row_mask:0xf bank_mask:0xf
    s_nop 1
    v_add_f32 v13, v13, v13 row_ror:2 row_mask:0xf bank_mask:0xf
    s_nop 1
    v_add_f32 v13, v13, v13 row_ror:1 row_mask:0xf bank_mask:0xf
    v_mov_b32 v7, v13
    s_nop 1
    v_permlane16_swap_b32 v13, v7
    s_nop 0
    v_add_f32 v13, v13, v7
    v_mov_b32 v7, v13
    s_nop 1
    v_permlane32_swap_b32 v13, v7
    s_nop 0
    v_add_f32 v13, v13, v7
    v_mul_f32 v13, 0x3acccccd, v13
    v_cvt_pk_bf16_f32 v6, 0, v6
    v_cvt_pk_bf16_f32 v13, 0, v13
    v_add_f32 v13, 0x3727c5ac, v13
    v_cvt_pk_bf16_f32 v13, 0, v13
    v_sqrt_f32 v13, v13
    s_nop 0
    v_cvt_pk_bf16_f32 v13, 0, v13
    v_rcp_f32 v7, v13
    s_nop 0
    v_lshlrev_b32 v140, 16, v16
    v_and_b32 v141, s72, v16
    v_lshlrev_b32 v142, 16, v17
    v_and_b32 v143, s72, v17
    v_lshlrev_b32 v144, 16, v18
    v_and_b32 v145, s72, v18
    v_lshlrev_b32 v146, 16, v19
    v_and_b32 v147, s72, v19
    v_lshlrev_b32 v148, 16, v20
    v_and_b32 v149, s72, v20
    v_lshlrev_b32 v150, 16, v21
    v_and_b32 v151, s72, v21
    v_lshlrev_b32 v152, 16, v22
    v_and_b32 v153, s72, v22
    v_lshlrev_b32 v154, 16, v23
    v_and_b32 v155, s72, v23
    v_lshlrev_b32 v156, 16, v24
    v_and_b32 v157, s72, v24
    v_lshlrev_b32 v158, 16, v25
    v_and_b32 v159, s72, v25
    v_sub_f32 v140, v140, v6
    v_sub_f32 v141, v141, v6
    v_sub_f32 v142, v142, v6
    v_sub_f32 v143, v143, v6
    v_sub_f32 v144, v144, v6
    v_sub_f32 v145, v145, v6
    v_sub_f32 v146, v146, v6
    v_sub_f32 v147, v147, v6
    v_sub_f32 v148, v148, v6
    v_sub_f32 v149, v149, v6
    v_sub_f32 v150, v150, v6
    v_sub_f32 v151, v151, v6
    v_sub_f32 v152, v152, v6
    v_sub_f32 v153, v153, v6
    v_sub_f32 v154, v154, v6
    v_sub_f32 v155, v155, v6
    v_sub_f32 v156, v156, v6
    v_sub_f32 v157, v157, v6
    v_sub_f32 v158, v158, v6
    v_sub_f32 v159, v159, v6
    v_cvt_pk_bf16_f32 v140, 0, v140
    v_cvt_pk_bf16_f32 v141, 0, v141
    v_cvt_pk_bf16_f32 v142, 0, v142
    v_cvt_pk_bf16_f32 v143, 0, v143
    v_cvt_pk_bf16_f32 v144, 0, v144
    v_cvt_pk_bf16_f32 v145, 0, v145
    v_cvt_pk_bf16_f32 v146, 0, v146
    v_cvt_pk_bf16_f32 v147, 0, v147
    v_cvt_pk_bf16_f32 v148, 0, v148
    v_cvt_pk_bf16_f32 v149, 0, v149
    v_cvt_pk_bf16_f32 v150, 0, v150
    v_cvt_pk_bf16_f32 v151, 0, v151
    v_cvt_pk_bf16_f32 v152, 0, v152
    v_cvt_pk_bf16_f32 v153, 0, v153
    v_cvt_pk_bf16_f32 v154, 0, v154
    v_cvt_pk_bf16_f32 v155, 0, v155
    v_cvt_pk_bf16_f32 v156, 0, v156
    v_cvt_pk_bf16_f32 v157, 0, v157
    v_cvt_pk_bf16_f32 v158, 0, v158
    v_cvt_pk_bf16_f32 v159, 0, v159
    v_mul_f32 v140, v140, v7
    v_mul_f32 v141, v141, v7
    v_mul_f32 v142, v142, v7
    v_mul_f32 v143, v143, v7
    v_mul_f32 v144, v144, v7
    v_mul_f32 v145, v145, v7
    v_mul_f32 v146, v146, v7
    v_mul_f32 v147, v147, v7
    v_mul_f32 v148, v148, v7
    v_mul_f32 v149, v149, v7
    v_mul_f32 v150, v150, v7
    v_mul_f32 v151, v151, v7
    v_mul_f32 v152, v152, v7
    v_mul_f32 v153, v153, v7
    v_mul_f32 v154, v154, v7
    v_mul_f32 v155, v155, v7
    v_mul_f32 v156, v156, v7
    v_mul_f32 v157, v157, v7
    v_mul_f32 v158, v158, v7
    v_mul_f32 v159, v159, v7
    v_cvt_pk_bf16_f32 v120, v140, 0
    v_cvt_pk_bf16_f32 v140, 0, v140
    v_cvt_pk_bf16_f32 v121, v141, 0
    v_cvt_pk_bf16_f32 v141, 0, v141
    v_cvt_pk_bf16_f32 v122, v142, 0
    v_cvt_pk_bf16_f32 v142, 0, v142
    v_cvt_pk_bf16_f32 v123, v143, 0
    v_cvt_pk_bf16_f32 v143, 0, v143
    v_cvt_pk_bf16_f32 v124, v144, 0
    v_cvt_pk_bf16_f32 v144, 0, v144
    v_cvt_pk_bf16_f32 v125, v145, 0
    v_cvt_pk_bf16_f32 v145, 0, v145
    v_cvt_pk_bf16_f32 v126, v146, 0
    v_cvt_pk_bf16_f32 v146, 0, v146
    v_cvt_pk_bf16_f32 v127, v147, 0
    v_cvt_pk_bf16_f32 v147, 0, v147
    v_cvt_pk_bf16_f32 v128, v148, 0
    v_cvt_pk_bf16_f32 v148, 0, v148
    v_cvt_pk_bf16_f32 v129, v149, 0
    v_cvt_pk_bf16_f32 v149, 0, v149
    v_cvt_pk_bf16_f32 v130, v150, 0
    v_cvt_pk_bf16_f32 v150, 0, v150
    v_cvt_pk_bf16_f32 v131, v151, 0
    v_cvt_pk_bf16_f32 v151, 0, v151
    v_cvt_pk_bf16_f32 v132, v152, 0
    v_cvt_pk_bf16_f32 v152, 0, v152
    v_cvt_pk_bf16_f32 v133, v153, 0
    v_cvt_pk_bf16_f32 v153, 0, v153
    v_cvt_pk_bf16_f32 v134, v154, 0
    v_cvt_pk_bf16_f32 v154, 0, v154
    v_cvt_pk_bf16_f32 v135, v155, 0
    v_cvt_pk_bf16_f32 v155, 0, v155
    v_cvt_pk_bf16_f32 v136, v156, 0
    v_cvt_pk_bf16_f32 v156, 0, v156
    v_cvt_pk_bf16_f32 v137, v157, 0
    v_cvt_pk_bf16_f32 v157, 0, v157
    v_cvt_pk_bf16_f32 v138, v158, 0
    v_cvt_pk_bf16_f32 v158, 0, v158
    v_cvt_pk_bf16_f32 v139, v159, 0
    v_cvt_pk_bf16_f32 v159, 0, v159
    s_waitcnt vmcnt(4)
    v_dot2_f32_bf16 v24, v40, v120, 0
    v_dot2_f32_bf16 v25, v40, v140, 0
    v_dot2_f32_bf16 v26, v41, v120, 0
    v_dot2_f32_bf16 v27, v41, v140, 0
    v_dot2_f32_bf16 v28, v42, v120, 0
    v_dot2_f32_bf16 v29, v42, v140, 0
    v_dot2_f32_bf16 v30, v43, v120, 0
    v_dot2_f32_bf16 v31, v43, v140, 0
    v_dot2_f32_bf16 v24, v44, v121, v24
    v_dot2_f32_bf16 v25, v44, v141, v25
    v_dot2_f32_bf16 v26, v45, v121, v26
    v_dot2_f32_bf16 v27, v45, v141, v27
    v_dot2_f32_bf16 v28, v46, v121, v28
    v_dot2_f32_bf16 v29, v46, v141, v29
    v_dot2_f32_bf16 v30, v47, v121, v30
    v_dot2_f32_bf16 v31, v47, v141, v31
    v_dot2_f32_bf16 v24, v48, v122, v24
    v_dot2_f32_bf16 v25, v48, v142, v25
    v_dot2_f32_bf16 v26, v49, v122, v26
    v_dot2_f32_bf16 v27, v49, v142, v27
    v_dot2_f32_bf16 v28, v50, v122, v28
    v_dot2_f32_bf16 v29, v50, v142, v29
    v_dot2_f32_bf16 v30, v51, v122, v30
    v_dot2_f32_bf16 v31, v51, v142, v31
    v_dot2_f32_bf16 v24, v52, v123, v24
    v_dot2_f32_bf16 v25, v52, v143, v25
    v_dot2_f32_bf16 v26, v53, v123, v26
    v_dot2_f32_bf16 v27, v53, v143, v27
    v_dot2_f32_bf16 v28, v54, v123, v28
    v_dot2_f32_bf16 v29, v54, v143, v29
    v_dot2_f32_bf16 v30, v55, v123, v30
    v_dot2_f32_bf16 v31, v55, v143, v31
    v_dot2_f32_bf16 v24, v56, v124, v24
    v_dot2_f32_bf16 v25, v56, v144, v25
    v_dot2_f32_bf16 v26, v57, v124, v26
    v_dot2_f32_bf16 v27, v57, v144, v27
    v_dot2_f32_bf16 v28, v58, v124, v28
    v_dot2_f32_bf16 v29, v58, v144, v29
    v_dot2_f32_bf16 v30, v59, v124, v30
    v_dot2_f32_bf16 v31, v59, v144, v31
    v_dot2_f32_bf16 v24, v60, v125, v24
    v_dot2_f32_bf16 v25, v60, v145, v25
    v_dot2_f32_bf16 v26, v61, v125, v26
    v_dot2_f32_bf16 v27, v61, v145, v27
    v_dot2_f32_bf16 v28, v62, v125, v28
    v_dot2_f32_bf16 v29, v62, v145, v29
    v_dot2_f32_bf16 v30, v63, v125, v30
    v_dot2_f32_bf16 v31, v63, v145, v31
    v_dot2_f32_bf16 v24, v64, v126, v24
    v_dot2_f32_bf16 v25, v64, v146, v25
    v_dot2_f32_bf16 v26, v65, v126, v26
    v_dot2_f32_bf16 v27, v65, v146, v27
    v_dot2_f32_bf16 v28, v66, v126, v28
    v_dot2_f32_bf16 v29, v66, v146, v29
    v_dot2_f32_bf16 v30, v67, v126, v30
    v_dot2_f32_bf16 v31, v67, v146, v31
    v_dot2_f32_bf16 v24, v68, v127, v24
    v_dot2_f32_bf16 v25, v68, v147, v25
    v_dot2_f32_bf16 v26, v69, v127, v26
    v_dot2_f32_bf16 v27, v69, v147, v27
    v_dot2_f32_bf16 v28, v70, v127, v28
    v_dot2_f32_bf16 v29, v70, v147, v29
    v_dot2_f32_bf16 v30, v71, v127, v30
    v_dot2_f32_bf16 v31, v71, v147, v31
    v_dot2_f32_bf16 v24, v72, v128, v24
    v_dot2_f32_bf16 v25, v72, v148, v25
    v_dot2_f32_bf16 v26, v73, v128, v26
    v_dot2_f32_bf16 v27, v73, v148, v27
    v_dot2_f32_bf16 v28, v74, v128, v28
    v_dot2_f32_bf16 v29, v74, v148, v29
    v_dot2_f32_bf16 v30, v75, v128, v30
    v_dot2_f32_bf16 v31, v75, v148, v31
    v_dot2_f32_bf16 v24, v76, v129, v24
    v_dot2_f32_bf16 v25, v76, v149, v25
    v_dot2_f32_bf16 v26, v77, v129, v26
    v_dot2_f32_bf16 v27, v77, v149, v27
    v_dot2_f32_bf16 v28, v78, v129, v28
    v_dot2_f32_bf16 v29, v78, v149, v29
    v_dot2_f32_bf16 v30, v79, v129, v30
    v_dot2_f32_bf16 v31, v79, v149, v31
    v_dot2_f32_bf16 v24, v80, v130, v24
    v_dot2_f32_bf16 v25, v80, v150, v25
    v_dot2_f32_bf16 v26, v81, v130, v26
    v_dot2_f32_bf16 v27, v81, v150, v27
    v_dot2_f32_bf16 v28, v82, v130, v28
    v_dot2_f32_bf16 v29, v82, v150, v29
    v_dot2_f32_bf16 v30, v83, v130, v30
    v_dot2_f32_bf16 v31, v83, v150, v31
    v_dot2_f32_bf16 v24, v84, v131, v24
    v_dot2_f32_bf16 v25, v84, v151, v25
    v_dot2_f32_bf16 v26, v85, v131, v26
    v_dot2_f32_bf16 v27, v85, v151, v27
    v_dot2_f32_bf16 v28, v86, v131, v28
    v_dot2_f32_bf16 v29, v86, v151, v29
    v_dot2_f32_bf16 v30, v87, v131, v30
    v_dot2_f32_bf16 v31, v87, v151, v31
    v_dot2_f32_bf16 v24, v88, v132, v24
    v_dot2_f32_bf16 v25, v88, v152, v25
    v_dot2_f32_bf16 v26, v89, v132, v26
    v_dot2_f32_bf16 v27, v89, v152, v27
    v_dot2_f32_bf16 v28, v90, v132, v28
    v_dot2_f32_bf16 v29, v90, v152, v29
    v_dot2_f32_bf16 v30, v91, v132, v30
    v_dot2_f32_bf16 v31, v91, v152, v31
    v_dot2_f32_bf16 v24, v92, v133, v24
    v_dot2_f32_bf16 v25, v92, v153, v25
    v_dot2_f32_bf16 v26, v93, v133, v26
    v_dot2_f32_bf16 v27, v93, v153, v27
    v_dot2_f32_bf16 v28, v94, v133, v28
    v_dot2_f32_bf16 v29, v94, v153, v29
    v_dot2_f32_bf16 v30, v95, v133, v30
    v_dot2_f32_bf16 v31, v95, v153, v31
    v_dot2_f32_bf16 v24, v96, v134, v24
    v_dot2_f32_bf16 v25, v96, v154, v25
    v_dot2_f32_bf16 v26, v97, v134, v26
    v_dot2_f32_bf16 v27, v97, v154, v27
    v_dot2_f32_bf16 v28, v98, v134, v28
    v_dot2_f32_bf16 v29, v98, v154, v29
    v_dot2_f32_bf16 v30, v99, v134, v30
    v_dot2_f32_bf16 v31, v99, v154, v31
    v_dot2_f32_bf16 v24, v100, v135, v24
    v_dot2_f32_bf16 v25, v100, v155, v25
    v_dot2_f32_bf16 v26, v101, v135, v26
    v_dot2_f32_bf16 v27, v101, v155, v27
    v_dot2_f32_bf16 v28, v102, v135, v28
    v_dot2_f32_bf16 v29, v102, v155, v29
    v_dot2_f32_bf16 v30, v103, v135, v30
    v_dot2_f32_bf16 v31, v103, v155, v31
    v_dot2_f32_bf16 v24, v104, v136, v24
    v_dot2_f32_bf16 v25, v104, v156, v25
    v_dot2_f32_bf16 v26, v105, v136, v26
    v_dot2_f32_bf16 v27, v105, v156, v27
    v_dot2_f32_bf16 v28, v106, v136, v28
    v_dot2_f32_bf16 v29, v106, v156, v29
    v_dot2_f32_bf16 v30, v107, v136, v30
    v_dot2_f32_bf16 v31, v107, v156, v31
    v_dot2_f32_bf16 v24, v108, v137, v24
    v_dot2_f32_bf16 v25, v108, v157, v25
    v_dot2_f32_bf16 v26, v109, v137, v26
    v_dot2_f32_bf16 v27, v109, v157, v27
    v_dot2_f32_bf16 v28, v110, v137, v28
    v_dot2_f32_bf16 v29, v110, v157, v29
    v_dot2_f32_bf16 v30, v111, v137, v30
    v_dot2_f32_bf16 v31, v111, v157, v31
    v_dot2_f32_bf16 v24, v112, v138, v24
    v_dot2_f32_bf16 v25, v112, v158, v25
    v_dot2_f32_bf16 v26, v113, v138, v26
    v_dot2_f32_bf16 v27, v113, v158, v27
    v_dot2_f32_bf16 v28, v114, v138, v28
    v_dot2_f32_bf16 v29, v114, v158, v29
    v_dot2_f32_bf16 v30, v115, v138, v30
    v_dot2_f32_bf16 v31, v115, v158, v31
    v_dot2_f32_bf16 v24, v116, v139, v24
    v_dot2_f32_bf16 v25, v116, v159, v25
    v_dot2_f32_bf16 v26, v117, v139, v26
    v_dot2_f32_bf16 v27, v117, v159, v27
    v_dot2_f32_bf16 v28, v118, v139, v28
    v_dot2_f32_bf16 v29, v118, v159, v29
    v_dot2_f32_bf16 v30, v119, v139, v30
    v_dot2_f32_bf16 v31, v119, v159, v31
    s_nop 2
    v_permlane32_swap_b32 v24, v28
    v_permlane32_swap_b32 v25, v29
    v_permlane32_swap_b32 v26, v30
    v_permlane32_swap_b32 v27, v31
    s_nop 0
    v_pk_add_f32 v[24:25], v[24:25], v[28:29]
    v_pk_add_f32 v[26:27], v[26:27], v[30:31]
    s_nop 1
    v_permlane16_swap_b32 v24, v26
    v_permlane16_swap_b32 v25, v27
    s_nop 0
    v_pk_add_f32 v[24:25], v[24:25], v[26:27]
    v_lshlrev_b32 v35, 3, v35
    v_lshl_add_u32 v34, v34, 5, v35
    s_lshl_b32 s14, s75, 10
    s_add_u32 s14, s14, 0x80000
    v_lshlrev_b32 v5, 1, v34
    v_mov_b32 v26, v25
    s_waitcnt vmcnt(0)
    v_add_u32 v14, 1, v14
    v_mov_b32 v25, v14
    v_mov_b32 v27, v14
    buffer_store_dwordx4 v[24:27], v5, s[52:55], s14 offen sc1
    s_lshl_b32 s15, s3, 2
    v_mov_b32 v8, 1
    s_mov_b64 exec, 1
    buffer_atomic_add v8, off, s[68:71], s15 offset:128 sc1
    s_mov_b64 exec, -1
    s_lshl_b32 s8, s3, 13
    s_add_u32 s8, s8, 0x80000
    s_add_u32 s9, s8, 0x1000
    v_lshlrev_b32 v5, 4, v0
    v_lshlrev_b32 v4, 3, v0
    s_mov_b32 s7, 0
L_pq:
    buffer_load_dwordx4 v[40:43], v5, s[52:55], s8 offen offset:0 sc1
    buffer_load_dwordx4 v[44:47], v5, s[52:55], s8 offen offset:1024 sc1
    buffer_load_dwordx4 v[48:51], v5, s[52:55], s8 offen offset:2048 sc1
    buffer_load_dwordx4 v[52:55], v5, s[52:55], s8 offen offset:3072 sc1
    buffer_load_dwordx4 v[56:59], v5, s[52:55], s9 offen offset:0 sc1
    buffer_load_dwordx4 v[60:63], v5, s[52:55], s9 offen offset:1024 sc1
    buffer_load_dwordx4 v[64:67], v5, s[52:55], s9 offen offset:2048 sc1
    buffer_load_dwordx4 v[68:71], v5, s[52:55], s9 offen offset:3072 sc1
    s_waitcnt vmcnt(0)
    v_xor_b32 v8, v14, v41
    v_xor_b32 v9, v14, v43
    v_or_b32 v8, v8, v9
    v_xor_b32 v9, v14, v45
    v_or_b32 v8, v8, v9
    v_xor_b32 v9, v14, v47
    v_or_b32 v8, v8, v9
    v_xor_b32 v9, v14, v49
    v_or_b32 v8, v8, v9
    v_xor_b32 v9, v14, v51
    v_or_b32 v8, v8, v9
    v_xor_b32 v9, v14, v53
    v_or_b32 v8, v8, v9
    v_xor_b32 v9, v14, v55
    v_or_b32 v8, v8, v9
    v_xor_b32 v9, v14, v57
    v_or_b32 v8, v8, v9
    v_xor_b32 v9, v14, v59
    v_or_b32 v8, v8, v9
    v_xor_b32 v9, v14, v61
    v_or_b32 v8, v8, v9
    v_xor_b32 v9, v14, v63
    v_or_b32 v8, v8, v9
    v_xor_b32 v9, v14, v65
    v_or_b32 v8, v8, v9
    v_xor_b32 v9, v14, v67
    v_or_b32 v8, v8, v9
    v_xor_b32 v9, v14, v69
    v_or_b32 v8, v8, v9
    v_xor_b32 v9, v14, v71
    v_or_b32 v8, v8, v9
    v_cmp_ne_u32 vcc, 0, v8
    s_add_u32 s7, s7, 1
    s_cmp_ge_u32 s7, 131072
    s_cbranch_scc1 L_pq_x
    s_cbranch_vccnz L_pq
L_pq_x:
    v_add_f32 v40, v40, v44
    v_add_f32 v42, v42, v46
    v_add_f32 v48, v48, v52
    v_add_f32 v50, v50, v54
    v_add_f32 v56, v56, v60
    v_add_f32 v58, v58, v62
    v_add_f32 v64, v64, v68
    v_add_f32 v66, v66, v70
    v_add_f32 v40, v40, v48
    v_add_f32 v42, v42, v50
    v_add_f32 v56, v56, v64
    v_add_f32 v58, v58, v66
    v_add_f32 v40, v40, v56
    v_add_f32 v42, v42, v58
    v_cvt_pk_bf16_f32 v8, v40, v42
    v_mov_b32 v9, 1
    v_mov_b32 v10, 0
    ds_write_b32 v1, v8 offset:0
    s_waitcnt lgkmcnt(0)
    ds_write_b32 v10, v9 offset:8320
    s_mov_b32 s81, 0
    s_mov_b32 s73, 0
    s_mov_b32 s74, 0
    s_mov_b64 exec, 0
    s_branch L_last
L_dry1:
    s_mov_b64 exec, -1
    v_and_b32 v5, 31, v0
    v_lshlrev_b32 v5, 2, v5
    s_mov_b32 s7, 0
L_pz:
    buffer_load_dword v8, v5, s[68:71], 0 offen offset:128 sc1
    s_waitcnt vmcnt(0)
    v_cmp_gt_u32 vcc, 8, v8
    s_add_u32 s7, s7, 1
    s_cmp_ge_u32 s7, 131072
    s_cbranch_scc1 L_pz_x
    s_cbranch_vccz L_pz_x
    s_sleep 8
    s_branch L_pz
L_pz_x:
    s_cmp_lg_u32 s2, 0
    s_cbranch_scc1 L_noep
    s_mov_b64 exec, 1
    buffer_store_dword v14, off, s[52:55], 0 offset:0 sc1
    s_mov_b64 exec, -1
L_noep:
    s_mov_b32 s60, s34
    s_and_b32 s61, s35, 0xffff
    s_mov_b32 s62, 0x500
    s_mov_b32 s63, 0x20000
    s_mov_b32 s68, s36
    s_and_b32 s69, s37, 0xffff
    s_mov_b32 s70, 0x500
    s_mov_b32 s71, 0x20000
    s_mov_b32 s14, 0x4d000
    s_add_u32 s64, s40, s14
    s_addc_u32 s65, s41, 0
    s_and_b32 s65, s65, 0xffff
    s_mov_b32 s66, 0x21c00
    s_mov_b32 s67, 0x20000
    s_sub_u32 s73, s2, 214
    s_lshl_b32 s74, s73, 6
    v_and_b32 v5, 7, v0
    v_bfe_u32 v6, v0, 4, 1
    v_lshlrev_b32 v6, 2, v6
    v_lshl_add_u32 v6, v5, 3, v6
    s_min_u32 s74, s74, 1216
    buffer_load_dword v36, v6, s[56:59], s74 offen
    buffer_load_dword v37, v6, s[60:63], s74 offen
    v_lshrrev_b32 v7, 3, v0
    v_mul_u32_u24 v7, 0xa00, v7
    v_lshl_add_u32 v7, v5, 4, v7
    s_mul_i32 s14, s75, 640
    s_add_u32 s14, s14, 0x20000
    v_mov_b32 v5, 0
    s_lshl_b32 s15, s73, 7
    v_add_u32 v7, s15, v7
    s_mov_b32 s84, 0
    s_mov_b32 s85, 20480
    s_mov_b32 s86, 40960
    s_mov_b32 s87, 61440
    s_mov_b32 s88, 81920
    s_mov_b32 s89, 102400
    v_add_u32 v39, 122880, v7
    s_mov_b32 s15, 0x48000
    s_mov_b64 exec, 0
    s_branch L_hp
L_dry2:
    s_mov_b64 exec, -1
    s_barrier
L_hp:
    ds_read_b128 v[112:115], v5 offset:4352
    ds_read_b128 v[116:119], v5 offset:4368
    ds_read_b128 v[120:123], v5 offset:4384
    ds_read_b128 v[124:127], v5 offset:4400
    ds_read_b64 v[8:9], v4 offset:256
    ds_read_b64 v[10:11], v4 offset:768
    ds_read_b64 v[12:13], v4 offset:1280
    ds_read_b64 v[14:15], v4 offset:1792
    ds_read_b64 v[16:17], v4 offset:2304
    ds_read_b64 v[18:19], v4 offset:2816
    ds_read_b64 v[20:21], v4 offset:3328
    ds_read_b64 v[22:23], v4 offset:3840
    s_waitcnt lgkmcnt(8)
    v_max3_f32 v26, v112, v114, v116
    v_max3_f32 v27, v118, v120, v122
    v_max3_f32 v26, v26, v124, v126
    v_max_f32 v26, v26, v27
    v_mul_f32 v28, s12, v26
    v_fma_f32 v112, v112, s12, -v28
    v_fma_f32 v114, v114, s12, -v28
    v_fma_f32 v116, v116, s12, -v28
    v_fma_f32 v118, v118, s12, -v28
    v_fma_f32 v120, v120, s12, -v28
    v_fma_f32 v122, v122, s12, -v28
    v_fma_f32 v124, v124, s12, -v28
    v_fma_f32 v126, v126, s12, -v28
    v_exp_f32 v112, v112
    v_exp_f32 v114, v114
    v_exp_f32 v116, v116
    v_exp_f32 v118, v118
    v_exp_f32 v120, v120
    v_exp_f32 v122, v122
    v_exp_f32 v124, v124
    v_exp_f32 v126, v126
    s_waitcnt lgkmcnt(0)
    v_mul_f32 v27, v112, v113
    v_pk_mul_f32 v[24:25], v[112:113], v[8:9] op_sel_hi:[0,1]
    v_fmac_f32 v27, v114, v115
    v_pk_fma_f32 v[24:25], v[114:115], v[10:11], v[24:25] op_sel_hi:[0,1,1]
    v_fmac_f32 v27, v116, v117
    v_pk_fma_f32 v[24:25], v[116:117], v[12:13], v[24:25] op_sel_hi:[0,1,1]
    v_fmac_f32 v27, v118, v119
    v_pk_fma_f32 v[24:25], v[118:119], v[14:15], v[24:25] op_sel_hi:[0,1,1]
    v_fmac_f32 v27, v120, v121
    v_pk_fma_f32 v[24:25], v[120:121], v[16:17], v[24:25] op_sel_hi:[0,1,1]
    v_fmac_f32 v27, v122, v123
    v_pk_fma_f32 v[24:25], v[122:123], v[18:19], v[24:25] op_sel_hi:[0,1,1]
    v_fmac_f32 v27, v124, v125
    v_pk_fma_f32 v[24:25], v[124:125], v[20:21], v[24:25] op_sel_hi:[0,1,1]
    v_fmac_f32 v27, v126, v127
    v_pk_fma_f32 v[24:25], v[126:127], v[22:23], v[24:25] op_sel_hi:[0,1,1]
    v_min_u32 v24, -2, v24
    v_min_u32 v25, -2, v25
    v_min_u32 v26, -2, v26
    v_min_u32 v27, -2, v27
    s_cbranch_execz L_sk11
    buffer_store_dwordx2 v[24:25], v4, s[52:55], s14 offen sc1
    s_mov_b64 exec, 1
    buffer_store_dwordx2 v[26:27], off, s[52:55], s14 offset:512 sc1
    s_mov_b64 exec, -1
L_sk11:
    s_cmp_lt_u32 s73, 20
    s_cbranch_scc0 L_hend
    s_cbranch_execz L_sk12
    s_mov_b32 s7, 0
L_lc:
    buffer_load_dword v44, v7, s[52:55], s15 offen sc1
    s_waitcnt vmcnt(0)
    v_cmp_eq_u32 vcc, -1, v44
    s_add_u32 s7, s7, 1
    s_cmp_ge_u32 s7, 131072
    s_cbranch_scc1 L_lc_x
    s_bcnt1_i32_b64 s76, vcc
    s_cmp_le_u32 s76, 0
    s_cbranch_scc1 L_lc_x
    s_sleep 4
    s_branch L_lc
L_lc_x:
L_sk12:
    s_mov_b32 s7, 0
L_pc:
    s_cbranch_execz L_sk13
    buffer_load_dwordx4 v[48:51], v7, s[64:67], s84 offen sc1
    buffer_load_dwordx4 v[52:55], v7, s[64:67], s85 offen sc1
    buffer_load_dwordx4 v[56:59], v7, s[64:67], s86 offen sc1
    buffer_load_dwordx4 v[60:63], v7, s[64:67], s87 offen sc1
    buffer_load_dwordx4 v[64:67], v7, s[64:67], s88 offen sc1
    buffer_load_dwordx4 v[68:71], v7, s[64:67], s89 offen sc1
    buffer_load_dwordx4 v[72:75], v39, s[64:67], 0 offen sc1
    buffer_load_dwordx4 v[44:47], v7, s[52:55], s15 offen sc1
L_sk13:
    s_waitcnt vmcnt(0)
    v_max_u32 v8, v44, v45
    v_max3_u32 v8, v8, v46, v47
    v_max3_u32 v8, v8, v48, v49
    v_max3_u32 v8, v8, v50, v51
    v_max3_u32 v8, v8, v52, v53
    v_max3_u32 v8, v8, v54, v55
    v_max3_u32 v8, v8, v56, v57
    v_max3_u32 v8, v8, v58, v59
    v_max3_u32 v8, v8, v60, v61
    v_max3_u32 v8, v8, v62, v63
    v_max3_u32 v8, v8, v64, v65
    v_max3_u32 v8, v8, v66, v67
    v_max3_u32 v8, v8, v68, v69
    v_max3_u32 v8, v8, v70, v71
    v_max3_u32 v8, v8, v72, v73
    v_max3_u32 v8, v8, v74, v75
    v_cmp_eq_u32 vcc, -1, v8
    s_add_u32 s7, s7, 1
    s_cmp_ge_u32 s7, 131072
    s_cbranch_scc1 L_pc_x
    s_cbranch_vccnz L_pc
L_pc_x:
    v_pk_add_f32 v[48:49], v[48:49], v[52:53]
    v_pk_add_f32 v[50:51], v[50:51], v[54:55]
    v_pk_add_f32 v[56:57], v[56:57], v[60:61]
    v_pk_add_f32 v[58:59], v[58:59], v[62:63]
    v_pk_add_f32 v[64:65], v[64:65], v[68:69]
    v_pk_add_f32 v[66:67], v[66:67], v[70:71]
    v_pk_add_f32 v[48:49], v[48:49], v[56:57]
    v_pk_add_f32 v[50:51], v[50:51], v[58:59]
    v_pk_add_f32 v[64:65], v[64:65], v[72:73]
    v_pk_add_f32 v[66:67], v[66:67], v[74:75]
    v_pk_add_f32 v[40:41], v[48:49], v[64:65]
    v_pk_add_f32 v[42:43], v[50:51], v[66:67]
    s_nop 1
    v_add_f32 v44, v44, v44 row_ror:8 row_mask:0xf bank_mask:0xf
    v_add_f32 v45, v45, v45 row_ror:8 row_mask:0xf bank_mask:0xf
    v_add_f32 v46, v46, v46 row_ror:8 row_mask:0xf bank_mask:0xf
    v_add_f32 v47, v47, v47 row_ror:8 row_mask:0xf bank_mask:0xf
    v_add_f32 v40, v40, v40 row_ror:8 row_mask:0xf bank_mask:0xf
    v_add_f32 v41, v41, v41 row_ror:8 row_mask:0xf bank_mask:0xf
    v_add_f32 v42, v42, v42 row_ror:8 row_mask:0xf bank_mask:0xf
    v_add_f32 v43, v43, v43 row_ror:8 row_mask:0xf bank_mask:0xf
    s_nop 2
    v_permlane32_swap_b32 v40, v44
    v_permlane32_swap_b32 v41, v45
    v_permlane32_swap_b32 v42, v46
    v_permlane32_swap_b32 v43, v47
    s_nop 0
    v_pk_add_f32 v[40:41], v[40:41], v[44:45]
    v_pk_add_f32 v[42:43], v[42:43], v[46:47]
    s_nop 1
    v_permlane16_swap_b32 v40, v42
    v_permlane16_swap_b32 v41, v43
    s_nop 0
    v_pk_add_f32 v[40:41], v[40:41], v[42:43]
    v_mov_b32 v42, v40
    v_mov_b32 v43, v41
    s_nop 1
    v_permlane32_swap_b32 v40, v42
    v_permlane32_swap_b32 v41, v43
    s_nop 0
    v_cvt_pk_bf16_f32 v40, 0, v40
    v_cvt_pk_bf16_f32 v41, 0, v41
    v_cvt_pk_bf16_f32 v42, 0, v42
    v_cvt_pk_bf16_f32 v43, 0, v43
    v_lshlrev_b32 v8, 16, v36
    v_and_b32 v9, s72, v36
    v_lshlrev_b32 v10, 16, v37
    v_and_b32 v11, s72, v37
    v_add_f32 v42, v42, v8
    v_add_f32 v43, v43, v9
    v_add_f32 v40, v40, v10
    v_add_f32 v41, v41, v11
    v_cvt_pk_bf16_f32 v40, 0, v40
    v_cvt_pk_bf16_f32 v41, 0, v41
    v_cvt_pk_bf16_f32 v42, 0, v42
    v_cvt_pk_bf16_f32 v43, 0, v43
    v_add_f32 v40, v40, v42
    v_add_f32 v41, v41, v43
    v_cvt_pk_bf16_f32 v40, v40, v41
    s_cbranch_execz L_sk14
    s_mov_b64 exec, 0x00ff00ff
    buffer_store_dword v40, v6, s[68:71], s74 offen
L_sk14:
L_hend:
    s_cbranch_execz L_dry2
    s_endpgm
L_end:
    s_endpgm
.section .rodata,"a"
.p2align 6
.amdhsa_kernel sequential_preLN__mha_block_cached__dense_activation_gelu__decode_kernel
  .amdhsa_next_free_vgpr 168
  .amdhsa_next_free_sgpr 96
  .amdhsa_accum_offset 168
  .amdhsa_group_segment_fixed_size 0
  .amdhsa_kernarg_size 104
  .amdhsa_user_sgpr_count 2
  .amdhsa_user_sgpr_kernarg_segment_ptr 1
  .amdhsa_system_sgpr_workgroup_id_x 1
.end_amdhsa_kernel
```
